```python
import torch

def _softmax(x, axis=-1):
    return torch.softmax(x, dim=axis)
def _gelu(x):
    return torch.nn.functional.gelu(x, approximate="tanh")
def _silu(x):
    return torch.nn.functional.silu(x)
def _sigmoid(x):
    return torch.sigmoid(x)
def _layernorm(x, axis=-1, eps=1e-5):
    m = x.mean(dim=axis, keepdim=True)
    v = x.var(dim=axis, keepdim=True, unbiased=False)
    return (x - m) / torch.sqrt(v + eps)
def _scatter_add(tgt, idx, src, axis=0):
    return tgt.clone().index_add_(axis, idx, src)
def _segment_sum(src, seg, n):
    out = torch.zeros((n,) + src.shape[1:], dtype=src.dtype)
    return out.index_add_(0, seg, src)
def _pad(x, pw):
    flat = tuple(v for pair in reversed(pw) for v in pair)
    return torch.nn.functional.pad(x, flat)

kernel_name = 'gated_mix__ssm_conv_h3__glu_gated_glu__prompt'

def setup_inputs():

    _w = (lambda a: (lambda t: t.to(torch.bfloat16) if t.is_floating_point() else t)(torch.as_tensor(a)))
    def _A_setup():
        B, S, D = 1, 2048, 640
        ks = 4
        return {
            "q": _w((lambda *s: torch.randn(*s, dtype=torch.bfloat16) * 0.05)(B, S, D)),
            "k": _w((lambda *s: torch.randn(*s, dtype=torch.bfloat16) * 0.4)(B, S, D)),
            "v": _w((lambda *s: torch.randn(*s, dtype=torch.bfloat16) * 0.4)(B, S, D)),
            "shift_k": _w((lambda *s: torch.randn(*s, dtype=torch.bfloat16) * 0.4)(D, ks) * 0.5),
            "ssm_k": _w((lambda *s: torch.randn(*s, dtype=torch.bfloat16) * 1.6)(D, S) * (1.0 / S ** 0.5)),
            "ssm_D": _w((lambda *s: torch.randn(*s, dtype=torch.bfloat16) * 0.4)(D)),
        }
    _A_in = _A_setup()

    def _B_setup():
        B, S, D, F = 1, 2048, 640, 1536
        return {
            "x": _w((lambda *s: torch.randn(*s, dtype=torch.bfloat16) * 0.05)(B, S, D)),
            "w_gate": _w((lambda *s: torch.randn(*s, dtype=torch.bfloat16) * 0.4)(D, F)),
            "w_up": _w((lambda *s: torch.randn(*s, dtype=torch.bfloat16) * 0.05)(D, F)),
            "w_down": _w((lambda *s: torch.randn(*s, dtype=torch.bfloat16) * 0.05)(F, D)),
        }
    _B_in = _B_setup()

    return {
        "A_q": _A_in["q"],
        "A_k": _A_in["k"],
        "A_v": _A_in["v"],
        "A_shift_k": _A_in["shift_k"],
        "A_ssm_k": _A_in["ssm_k"],
        "A_ssm_D": _A_in["ssm_D"],
        "B_x": _B_in["x"],
        "B_w_gate": _B_in["w_gate"],
        "B_w_up": _B_in["w_up"],
        "B_w_down": _B_in["w_down"],
        "gate_w": _w((lambda *s: torch.randn(*s, dtype=torch.bfloat16) * 0.05)(640) * 16.0),
    }

def reference(A_q, A_k, A_v, A_shift_k, A_ssm_k, A_ssm_D, B_x, B_w_gate, B_w_up, B_w_down, gate_w):
    def _A_ref(q, k, v, shift_k, ssm_k, ssm_D):
        B, S, D = q.shape
        ks = shift_k.shape[-1]
        k_pad = _pad(k, ((0, 0), (ks - 1, 0), (0, 0)))
        k_shift = torch.zeros_like(k)
        for t in range(ks):
            k_shift = k_shift + k_pad[:, t:t + S, :] * shift_k[:, ks - 1 - t][None, None, :]
        kv = k_shift * v
        L = 2 * S
        kv_pad = _pad(kv, ((0, 0), (0, S), (0, 0)))
        kf_pad = _pad(ssm_k, ((0, 0), (0, S)))
        kv_f = (lambda x, axes=(-2,-1): torch.fft.rfft2(x.float(), dim=axes))(kv_pad[:, None, :, :], axes=(1, 2))
        kf_f = (lambda x, axes=(-2,-1): torch.fft.rfft2(x.float(), dim=axes))(kf_pad[:, None, :], axes=(1, 2))
        kf_f = (lambda x, *d: x.permute(*d))(kf_f, 1, 2, 0)
        y_f = kv_f * kf_f[None, :, :, :]
        y = (lambda x, s, axes=(-2,-1): torch.fft.irfft2(x, s=s, dim=axes).to(torch.bfloat16))(y_f, (1, L), axes=(1, 2))[:, 0, :S, :]
        y = y + kv * ssm_D[None, None, :]
        return q * y

    def _B_ref(x, w_gate, w_up, w_down):
        g = torch.einsum("bsd,df->bsf", x, w_gate)
        u = torch.einsum("bsd,df->bsf", x, w_up)
        h = _sigmoid(g) * u
        return torch.einsum("bsf,fd->bsd", h, w_down)

    x = A_q
    g = _sigmoid((x * gate_w).sum(-1, keepdims=True))
    a = _A_ref(x, A_k, A_v, A_shift_k, A_ssm_k, A_ssm_D)
    b = _B_ref(x, B_w_gate, B_w_up, B_w_down)
    return g * a + (1 - g) * b
```

```asm
; @launch grid=(256,1,1) block=(512,1,1) lds=163840
.amdgcn_target "amdgcn-amd-amdhsa--gfx950"
.text
.globl gated_mix__ssm_conv_h3__glu_gated_glu__prompt_kernel
.p2align 8
.type gated_mix__ssm_conv_h3__glu_gated_glu__prompt_kernel,@function
gated_mix__ssm_conv_h3__glu_gated_glu__prompt_kernel:
    s_cmp_ge_u32 s2, 256
    s_cbranch_scc1 L_end
    s_load_dwordx16 s[16:31], s[0:1], 0
    s_load_dwordx8 s[32:39], s[0:1], 64
    s_load_dwordx4 s[40:43], s[0:1], 96
    v_lshrrev_b32 v2, 6, v0
    v_and_b32 v1, 63, v0
    v_readfirstlane_b32 s3, v2
    s_and_b32 s4, s2, 7
    s_lshr_b32 s5, s2, 3
    s_lshr_b32 s6, s4, 2
    s_lshl_b32 s6, s6, 3
    s_and_b32 s11, s5, 7
    s_add_u32 s6, s6, s11
    s_and_b32 s7, s4, 3
    s_lshl_b32 s7, s7, 2
    s_lshr_b32 s12, s5, 3
    s_add_u32 s7, s7, s12
    s_lshl_b32 s8, s12, 1
    s_add_u32 s8, s8, s11
    s_and_b32 s8, s8, 7
    s_lshr_b32 s9, s4, 1
    s_lshl_b32 s9, s9, 3
    s_add_u32 s9, s9, s11
    s_and_b32 s10, s4, 1
    s_lshl_b32 s10, s10, 2
    s_add_u32 s10, s10, s12
    s_mov_b32 s14, s2
    v_lshlrev_b32 v12, 4, v1
    s_cmp_lt_u32 s3, 4
    s_cbranch_scc1 L_X
    s_cmp_ge_u32 s3, 6
    s_cbranch_scc1 L_C
L_L:
    s_setprio 3
    s_sub_u32 s74, s3, 4
    v_lshrrev_b32 v4, 2, v1
    v_mul_u32_u24 v2, 3072, v4
    v_and_b32 v5, 3, v1
    v_lshrrev_b32 v6, 5, v1
    v_lshlrev_b32 v6, 1, v6
    v_xor_b32 v6, v6, v5
    v_lshl_add_u32 v2, v6, 4, v2
    s_mul_i32 s75, s7, 192
    v_add_u32 v2, s75, v2
    v_mul_u32_u24 v3, 1280, v4
    v_lshrrev_b32 v7, 5, v1
    v_bfe_u32 v6, v1, 4, 1
    v_xor_b32 v6, v6, v7
    v_lshl_add_u32 v6, v6, 1, v7
    v_xor_b32 v6, v6, v5
    v_lshl_add_u32 v3, v6, 4, v3
    s_lshl_b32 s75, s6, 3
    s_add_u32 s75, s75, s74
    s_mul_i32 s75, s75, 20480
    v_add_u32 v3, s75, v3
    s_lshl_b32 s78, s74, 10
    s_mul_i32 s79, s74, 6144
    s_add_u32 s79, s79, 32768
    s_waitcnt lgkmcnt(0)
    s_mov_b32 s44, s42
    s_and_b32 s45, s43, 0xffff
    s_mov_b32 s46, 268435456
    s_mov_b32 s47, 0x20000
    s_mov_b32 s48, s16
    s_and_b32 s49, s17, 0xffff
    s_mov_b32 s50, 2621440
    s_mov_b32 s51, 0x20000
    s_cmp_eq_u32 s74, 0
    s_cselect_b32 s52, s30, s32
    s_cselect_b32 s53, s31, s33
    s_and_b32 s53, s53, 0xffff
    s_mov_b32 s54, 1966080
    s_mov_b32 s55, 0x20000
    s_mul_i32 s8, s8, 5
    s_lshr_b32 s8, s8, 2
    s_add_u32 s80, s8, 0
    s_cmp_ge_u32 s80, 10
    s_cselect_b32 s15, 10, 0
    s_sub_u32 s80, s80, s15
    s_mul_i32 s81, s80, 196608
    s_add_u32 m0, s79, 0
    s_add_u32 s82, s81, 0
    buffer_load_dwordx4 v2, s[52:55], s82 offen lds
    s_add_u32 m0, s79, 2048
    s_add_u32 s82, s81, 64
    buffer_load_dwordx4 v2, s[52:55], s82 offen lds
    s_add_u32 m0, s79, 4096
    s_add_u32 s82, s81, 128
    buffer_load_dwordx4 v2, s[52:55], s82 offen lds
    s_add_u32 m0, s79, 1024
    s_add_u32 s82, s81, 49152
    buffer_load_dwordx4 v2, s[52:55], s82 offen lds
    s_add_u32 m0, s79, 3072
    s_add_u32 s82, s81, 49216
    buffer_load_dwordx4 v2, s[52:55], s82 offen lds
    s_add_u32 m0, s79, 5120
    s_add_u32 s82, s81, 49280
    buffer_load_dwordx4 v2, s[52:55], s82 offen lds
    s_add_u32 s80, s8, 0
    s_cmp_ge_u32 s80, 10
    s_cselect_b32 s15, 10, 0
    s_sub_u32 s80, s80, s15
    s_lshl_b32 s81, s80, 7
    s_add_u32 m0, s78, 0
    s_add_u32 s82, s81, 0
    buffer_load_dwordx4 v3, s[48:51], s82 offen lds
    s_add_u32 m0, s78, 8192
    s_add_u32 s82, s81, 64
    buffer_load_dwordx4 v3, s[48:51], s82 offen lds
    s_add_u32 m0, s78, 2048
    s_add_u32 s82, s81, 40960
    buffer_load_dwordx4 v3, s[48:51], s82 offen lds
    s_add_u32 m0, s78, 10240
    s_add_u32 s82, s81, 41024
    buffer_load_dwordx4 v3, s[48:51], s82 offen lds
    s_add_u32 m0, s78, 4096
    s_add_u32 s82, s81, 81920
    buffer_load_dwordx4 v3, s[48:51], s82 offen lds
    s_add_u32 m0, s78, 12288
    s_add_u32 s82, s81, 81984
    buffer_load_dwordx4 v3, s[48:51], s82 offen lds
    s_add_u32 m0, s78, 6144
    s_add_u32 s82, s81, 122880
    buffer_load_dwordx4 v3, s[48:51], s82 offen lds
    s_add_u32 m0, s78, 14336
    s_add_u32 s82, s81, 122944
    buffer_load_dwordx4 v3, s[48:51], s82 offen lds
    s_add_u32 s80, s8, 0
    s_cmp_ge_u32 s80, 10
    s_cselect_b32 s15, 10, 0
    s_sub_u32 s80, s80, s15
    s_mul_i32 s81, s80, 196608
    s_add_u32 m0, s79, 12288
    s_add_u32 s82, s81, 98304
    buffer_load_dwordx4 v2, s[52:55], s82 offen lds
    s_add_u32 m0, s79, 14336
    s_add_u32 s82, s81, 98368
    buffer_load_dwordx4 v2, s[52:55], s82 offen lds
    s_add_u32 m0, s79, 16384
    s_add_u32 s82, s81, 98432
    buffer_load_dwordx4 v2, s[52:55], s82 offen lds
    s_add_u32 m0, s79, 13312
    s_add_u32 s82, s81, 147456
    buffer_load_dwordx4 v2, s[52:55], s82 offen lds
    s_add_u32 m0, s79, 15360
    s_add_u32 s82, s81, 147520
    buffer_load_dwordx4 v2, s[52:55], s82 offen lds
    s_add_u32 m0, s79, 17408
    s_add_u32 s82, s81, 147584
    buffer_load_dwordx4 v2, s[52:55], s82 offen lds
    s_barrier
    s_waitcnt vmcnt(6)
    s_barrier
    s_waitcnt vmcnt(0)
    s_barrier
    s_barrier
    s_add_u32 s80, s8, 1
    s_cmp_ge_u32 s80, 10
    s_cselect_b32 s15, 10, 0
    s_sub_u32 s80, s80, s15
    s_lshl_b32 s81, s80, 7
    s_add_u32 m0, s78, 16384
    s_add_u32 s82, s81, 0
    buffer_load_dwordx4 v3, s[48:51], s82 offen lds
    s_add_u32 m0, s78, 24576
    s_add_u32 s82, s81, 64
    buffer_load_dwordx4 v3, s[48:51], s82 offen lds
    s_add_u32 m0, s78, 18432
    s_add_u32 s82, s81, 40960
    buffer_load_dwordx4 v3, s[48:51], s82 offen lds
    s_add_u32 m0, s78, 26624
    s_add_u32 s82, s81, 41024
    buffer_load_dwordx4 v3, s[48:51], s82 offen lds
    s_add_u32 m0, s78, 20480
    s_add_u32 s82, s81, 81920
    buffer_load_dwordx4 v3, s[48:51], s82 offen lds
    s_add_u32 m0, s78, 28672
    s_add_u32 s82, s81, 81984
    buffer_load_dwordx4 v3, s[48:51], s82 offen lds
    s_add_u32 m0, s78, 22528
    s_add_u32 s82, s81, 122880
    buffer_load_dwordx4 v3, s[48:51], s82 offen lds
    s_add_u32 m0, s78, 30720
    s_add_u32 s82, s81, 122944
    buffer_load_dwordx4 v3, s[48:51], s82 offen lds
    s_add_u32 s80, s8, 1
    s_cmp_ge_u32 s80, 10
    s_cselect_b32 s15, 10, 0
    s_sub_u32 s80, s80, s15
    s_mul_i32 s81, s80, 196608
    s_add_u32 m0, s79, 24576
    s_add_u32 s82, s81, 0
    buffer_load_dwordx4 v2, s[52:55], s82 offen lds
    s_add_u32 m0, s79, 26624
    s_add_u32 s82, s81, 64
    buffer_load_dwordx4 v2, s[52:55], s82 offen lds
    s_add_u32 m0, s79, 28672
    s_add_u32 s82, s81, 128
    buffer_load_dwordx4 v2, s[52:55], s82 offen lds
    s_add_u32 m0, s79, 25600
    s_add_u32 s82, s81, 49152
    buffer_load_dwordx4 v2, s[52:55], s82 offen lds
    s_add_u32 m0, s79, 27648
    s_add_u32 s82, s81, 49216
    buffer_load_dwordx4 v2, s[52:55], s82 offen lds
    s_add_u32 m0, s79, 29696
    s_add_u32 s82, s81, 49280
    buffer_load_dwordx4 v2, s[52:55], s82 offen lds
    s_add_u32 s80, s8, 1
    s_cmp_ge_u32 s80, 10
    s_cselect_b32 s15, 10, 0
    s_sub_u32 s80, s80, s15
    s_mul_i32 s81, s80, 196608
    s_add_u32 m0, s79, 36864
    s_add_u32 s82, s81, 98304
    buffer_load_dwordx4 v2, s[52:55], s82 offen lds
    s_add_u32 m0, s79, 38912
    s_add_u32 s82, s81, 98368
    buffer_load_dwordx4 v2, s[52:55], s82 offen lds
    s_add_u32 m0, s79, 40960
    s_add_u32 s82, s81, 98432
    buffer_load_dwordx4 v2, s[52:55], s82 offen lds
    s_add_u32 m0, s79, 37888
    s_add_u32 s82, s81, 147456
    buffer_load_dwordx4 v2, s[52:55], s82 offen lds
    s_add_u32 m0, s79, 39936
    s_add_u32 s82, s81, 147520
    buffer_load_dwordx4 v2, s[52:55], s82 offen lds
    s_add_u32 m0, s79, 41984
    s_add_u32 s82, s81, 147584
    buffer_load_dwordx4 v2, s[52:55], s82 offen lds
    s_add_u32 s80, s8, 2
    s_cmp_ge_u32 s80, 10
    s_cselect_b32 s15, 10, 0
    s_sub_u32 s80, s80, s15
    s_mul_i32 s81, s80, 196608
    s_add_u32 m0, s79, 0
    s_add_u32 s82, s81, 0
    buffer_load_dwordx4 v2, s[52:55], s82 offen lds
    s_add_u32 m0, s79, 2048
    s_add_u32 s82, s81, 64
    buffer_load_dwordx4 v2, s[52:55], s82 offen lds
    s_add_u32 m0, s79, 4096
    s_add_u32 s82, s81, 128
    buffer_load_dwordx4 v2, s[52:55], s82 offen lds
    s_add_u32 m0, s79, 1024
    s_add_u32 s82, s81, 49152
    buffer_load_dwordx4 v2, s[52:55], s82 offen lds
    s_add_u32 m0, s79, 3072
    s_add_u32 s82, s81, 49216
    buffer_load_dwordx4 v2, s[52:55], s82 offen lds
    s_add_u32 m0, s79, 5120
    s_add_u32 s82, s81, 49280
    buffer_load_dwordx4 v2, s[52:55], s82 offen lds
    s_waitcnt vmcnt(12)
    s_barrier
    s_add_u32 s80, s8, 2
    s_cmp_ge_u32 s80, 10
    s_cselect_b32 s15, 10, 0
    s_sub_u32 s80, s80, s15
    s_lshl_b32 s81, s80, 7
    s_add_u32 m0, s78, 0
    s_add_u32 s82, s81, 0
    buffer_load_dwordx4 v3, s[48:51], s82 offen lds
    s_add_u32 m0, s78, 8192
    s_add_u32 s82, s81, 64
    buffer_load_dwordx4 v3, s[48:51], s82 offen lds
    s_add_u32 m0, s78, 2048
    s_add_u32 s82, s81, 40960
    buffer_load_dwordx4 v3, s[48:51], s82 offen lds
    s_add_u32 m0, s78, 10240
    s_add_u32 s82, s81, 41024
    buffer_load_dwordx4 v3, s[48:51], s82 offen lds
    s_add_u32 m0, s78, 4096
    s_add_u32 s82, s81, 81920
    buffer_load_dwordx4 v3, s[48:51], s82 offen lds
    s_add_u32 m0, s78, 12288
    s_add_u32 s82, s81, 81984
    buffer_load_dwordx4 v3, s[48:51], s82 offen lds
    s_add_u32 m0, s78, 6144
    s_add_u32 s82, s81, 122880
    buffer_load_dwordx4 v3, s[48:51], s82 offen lds
    s_add_u32 m0, s78, 14336
    s_add_u32 s82, s81, 122944
    buffer_load_dwordx4 v3, s[48:51], s82 offen lds
    s_add_u32 s80, s8, 2
    s_cmp_ge_u32 s80, 10
    s_cselect_b32 s15, 10, 0
    s_sub_u32 s80, s80, s15
    s_mul_i32 s81, s80, 196608
    s_add_u32 m0, s79, 12288
    s_add_u32 s82, s81, 98304
    buffer_load_dwordx4 v2, s[52:55], s82 offen lds
    s_add_u32 m0, s79, 14336
    s_add_u32 s82, s81, 98368
    buffer_load_dwordx4 v2, s[52:55], s82 offen lds
    s_add_u32 m0, s79, 16384
    s_add_u32 s82, s81, 98432
    buffer_load_dwordx4 v2, s[52:55], s82 offen lds
    s_add_u32 m0, s79, 13312
    s_add_u32 s82, s81, 147456
    buffer_load_dwordx4 v2, s[52:55], s82 offen lds
    s_add_u32 m0, s79, 15360
    s_add_u32 s82, s81, 147520
    buffer_load_dwordx4 v2, s[52:55], s82 offen lds
    s_add_u32 m0, s79, 17408
    s_add_u32 s82, s81, 147584
    buffer_load_dwordx4 v2, s[52:55], s82 offen lds
    s_waitcnt vmcnt(20)
    s_barrier
    s_add_u32 s80, s8, 3
    s_cmp_ge_u32 s80, 10
    s_cselect_b32 s15, 10, 0
    s_sub_u32 s80, s80, s15
    s_mul_i32 s81, s80, 196608
    s_add_u32 m0, s79, 24576
    s_add_u32 s82, s81, 0
    buffer_load_dwordx4 v2, s[52:55], s82 offen lds
    s_add_u32 m0, s79, 26624
    s_add_u32 s82, s81, 64
    buffer_load_dwordx4 v2, s[52:55], s82 offen lds
    s_add_u32 m0, s79, 28672
    s_add_u32 s82, s81, 128
    buffer_load_dwordx4 v2, s[52:55], s82 offen lds
    s_add_u32 m0, s79, 25600
    s_add_u32 s82, s81, 49152
    buffer_load_dwordx4 v2, s[52:55], s82 offen lds
    s_add_u32 m0, s79, 27648
    s_add_u32 s82, s81, 49216
    buffer_load_dwordx4 v2, s[52:55], s82 offen lds
    s_add_u32 m0, s79, 29696
    s_add_u32 s82, s81, 49280
    buffer_load_dwordx4 v2, s[52:55], s82 offen lds
    s_waitcnt vmcnt(12)
    s_barrier
    s_add_u32 s80, s8, 3
    s_cmp_ge_u32 s80, 10
    s_cselect_b32 s15, 10, 0
    s_sub_u32 s80, s80, s15
    s_lshl_b32 s81, s80, 7
    s_add_u32 m0, s78, 16384
    s_add_u32 s82, s81, 0
    buffer_load_dwordx4 v3, s[48:51], s82 offen lds
    s_add_u32 m0, s78, 24576
    s_add_u32 s82, s81, 64
    buffer_load_dwordx4 v3, s[48:51], s82 offen lds
    s_add_u32 m0, s78, 18432
    s_add_u32 s82, s81, 40960
    buffer_load_dwordx4 v3, s[48:51], s82 offen lds
    s_add_u32 m0, s78, 26624
    s_add_u32 s82, s81, 41024
    buffer_load_dwordx4 v3, s[48:51], s82 offen lds
    s_add_u32 m0, s78, 20480
    s_add_u32 s82, s81, 81920
    buffer_load_dwordx4 v3, s[48:51], s82 offen lds
    s_add_u32 m0, s78, 28672
    s_add_u32 s82, s81, 81984
    buffer_load_dwordx4 v3, s[48:51], s82 offen lds
    s_add_u32 m0, s78, 22528
    s_add_u32 s82, s81, 122880
    buffer_load_dwordx4 v3, s[48:51], s82 offen lds
    s_add_u32 m0, s78, 30720
    s_add_u32 s82, s81, 122944
    buffer_load_dwordx4 v3, s[48:51], s82 offen lds
    s_add_u32 s80, s8, 3
    s_cmp_ge_u32 s80, 10
    s_cselect_b32 s15, 10, 0
    s_sub_u32 s80, s80, s15
    s_mul_i32 s81, s80, 196608
    s_add_u32 m0, s79, 36864
    s_add_u32 s82, s81, 98304
    buffer_load_dwordx4 v2, s[52:55], s82 offen lds
    s_add_u32 m0, s79, 38912
    s_add_u32 s82, s81, 98368
    buffer_load_dwordx4 v2, s[52:55], s82 offen lds
    s_add_u32 m0, s79, 40960
    s_add_u32 s82, s81, 98432
    buffer_load_dwordx4 v2, s[52:55], s82 offen lds
    s_add_u32 m0, s79, 37888
    s_add_u32 s82, s81, 147456
    buffer_load_dwordx4 v2, s[52:55], s82 offen lds
    s_add_u32 m0, s79, 39936
    s_add_u32 s82, s81, 147520
    buffer_load_dwordx4 v2, s[52:55], s82 offen lds
    s_add_u32 m0, s79, 41984
    s_add_u32 s82, s81, 147584
    buffer_load_dwordx4 v2, s[52:55], s82 offen lds
    s_waitcnt vmcnt(20)
    s_barrier
    s_add_u32 s80, s8, 4
    s_cmp_ge_u32 s80, 10
    s_cselect_b32 s15, 10, 0
    s_sub_u32 s80, s80, s15
    s_mul_i32 s81, s80, 196608
    s_add_u32 m0, s79, 0
    s_add_u32 s82, s81, 0
    buffer_load_dwordx4 v2, s[52:55], s82 offen lds
    s_add_u32 m0, s79, 2048
    s_add_u32 s82, s81, 64
    buffer_load_dwordx4 v2, s[52:55], s82 offen lds
    s_add_u32 m0, s79, 4096
    s_add_u32 s82, s81, 128
    buffer_load_dwordx4 v2, s[52:55], s82 offen lds
    s_add_u32 m0, s79, 1024
    s_add_u32 s82, s81, 49152
    buffer_load_dwordx4 v2, s[52:55], s82 offen lds
    s_add_u32 m0, s79, 3072
    s_add_u32 s82, s81, 49216
    buffer_load_dwordx4 v2, s[52:55], s82 offen lds
    s_add_u32 m0, s79, 5120
    s_add_u32 s82, s81, 49280
    buffer_load_dwordx4 v2, s[52:55], s82 offen lds
    s_waitcnt vmcnt(12)
    s_barrier
    s_add_u32 s80, s8, 4
    s_cmp_ge_u32 s80, 10
    s_cselect_b32 s15, 10, 0
    s_sub_u32 s80, s80, s15
    s_lshl_b32 s81, s80, 7
    s_add_u32 m0, s78, 0
    s_add_u32 s82, s81, 0
    buffer_load_dwordx4 v3, s[48:51], s82 offen lds
    s_add_u32 m0, s78, 8192
    s_add_u32 s82, s81, 64
    buffer_load_dwordx4 v3, s[48:51], s82 offen lds
    s_add_u32 m0, s78, 2048
    s_add_u32 s82, s81, 40960
    buffer_load_dwordx4 v3, s[48:51], s82 offen lds
    s_add_u32 m0, s78, 10240
    s_add_u32 s82, s81, 41024
    buffer_load_dwordx4 v3, s[48:51], s82 offen lds
    s_add_u32 m0, s78, 4096
    s_add_u32 s82, s81, 81920
    buffer_load_dwordx4 v3, s[48:51], s82 offen lds
    s_add_u32 m0, s78, 12288
    s_add_u32 s82, s81, 81984
    buffer_load_dwordx4 v3, s[48:51], s82 offen lds
    s_add_u32 m0, s78, 6144
    s_add_u32 s82, s81, 122880
    buffer_load_dwordx4 v3, s[48:51], s82 offen lds
    s_add_u32 m0, s78, 14336
    s_add_u32 s82, s81, 122944
    buffer_load_dwordx4 v3, s[48:51], s82 offen lds
    s_add_u32 s80, s8, 4
    s_cmp_ge_u32 s80, 10
    s_cselect_b32 s15, 10, 0
    s_sub_u32 s80, s80, s15
    s_mul_i32 s81, s80, 196608
    s_add_u32 m0, s79, 12288
    s_add_u32 s82, s81, 98304
    buffer_load_dwordx4 v2, s[52:55], s82 offen lds
    s_add_u32 m0, s79, 14336
    s_add_u32 s82, s81, 98368
    buffer_load_dwordx4 v2, s[52:55], s82 offen lds
    s_add_u32 m0, s79, 16384
    s_add_u32 s82, s81, 98432
    buffer_load_dwordx4 v2, s[52:55], s82 offen lds
    s_add_u32 m0, s79, 13312
    s_add_u32 s82, s81, 147456
    buffer_load_dwordx4 v2, s[52:55], s82 offen lds
    s_add_u32 m0, s79, 15360
    s_add_u32 s82, s81, 147520
    buffer_load_dwordx4 v2, s[52:55], s82 offen lds
    s_add_u32 m0, s79, 17408
    s_add_u32 s82, s81, 147584
    buffer_load_dwordx4 v2, s[52:55], s82 offen lds
    s_waitcnt vmcnt(20)
    s_barrier
    s_add_u32 s80, s8, 5
    s_cmp_ge_u32 s80, 10
    s_cselect_b32 s15, 10, 0
    s_sub_u32 s80, s80, s15
    s_mul_i32 s81, s80, 196608
    s_add_u32 m0, s79, 24576
    s_add_u32 s82, s81, 0
    buffer_load_dwordx4 v2, s[52:55], s82 offen lds
    s_add_u32 m0, s79, 26624
    s_add_u32 s82, s81, 64
    buffer_load_dwordx4 v2, s[52:55], s82 offen lds
    s_add_u32 m0, s79, 28672
    s_add_u32 s82, s81, 128
    buffer_load_dwordx4 v2, s[52:55], s82 offen lds
    s_add_u32 m0, s79, 25600
    s_add_u32 s82, s81, 49152
    buffer_load_dwordx4 v2, s[52:55], s82 offen lds
    s_add_u32 m0, s79, 27648
    s_add_u32 s82, s81, 49216
    buffer_load_dwordx4 v2, s[52:55], s82 offen lds
    s_add_u32 m0, s79, 29696
    s_add_u32 s82, s81, 49280
    buffer_load_dwordx4 v2, s[52:55], s82 offen lds
    s_mov_b32 s60, s24
    s_and_b32 s61, s25, 0xffff
    s_mov_b32 s62, 2621440
    s_mov_b32 s63, 0x20000
    s_lshl_b32 s76, s14, 2
    s_add_u32 s76, s76, s74
    s_lshl_b32 s76, s76, 12
    buffer_load_dwordx4 v[164:167], v12, s[60:63], s76 offen offset:0
    buffer_load_dwordx4 v[168:171], v12, s[60:63], s76 offen offset:1024
    buffer_load_dwordx4 v[172:175], v12, s[60:63], s76 offen offset:2048
    buffer_load_dwordx4 v[176:179], v12, s[60:63], s76 offen offset:3072
    s_waitcnt vmcnt(16)
    s_barrier
    s_add_u32 s80, s8, 5
    s_cmp_ge_u32 s80, 10
    s_cselect_b32 s15, 10, 0
    s_sub_u32 s80, s80, s15
    s_lshl_b32 s81, s80, 7
    s_add_u32 m0, s78, 16384
    s_add_u32 s82, s81, 0
    buffer_load_dwordx4 v3, s[48:51], s82 offen lds
    s_add_u32 m0, s78, 24576
    s_add_u32 s82, s81, 64
    buffer_load_dwordx4 v3, s[48:51], s82 offen lds
    s_add_u32 m0, s78, 18432
    s_add_u32 s82, s81, 40960
    buffer_load_dwordx4 v3, s[48:51], s82 offen lds
    s_add_u32 m0, s78, 26624
    s_add_u32 s82, s81, 41024
    buffer_load_dwordx4 v3, s[48:51], s82 offen lds
    s_add_u32 m0, s78, 20480
    s_add_u32 s82, s81, 81920
    buffer_load_dwordx4 v3, s[48:51], s82 offen lds
    s_add_u32 m0, s78, 28672
    s_add_u32 s82, s81, 81984
    buffer_load_dwordx4 v3, s[48:51], s82 offen lds
    s_add_u32 m0, s78, 22528
    s_add_u32 s82, s81, 122880
    buffer_load_dwordx4 v3, s[48:51], s82 offen lds
    s_add_u32 m0, s78, 30720
    s_add_u32 s82, s81, 122944
    buffer_load_dwordx4 v3, s[48:51], s82 offen lds
    s_add_u32 s80, s8, 5
    s_cmp_ge_u32 s80, 10
    s_cselect_b32 s15, 10, 0
    s_sub_u32 s80, s80, s15
    s_mul_i32 s81, s80, 196608
    s_add_u32 m0, s79, 36864
    s_add_u32 s82, s81, 98304
    buffer_load_dwordx4 v2, s[52:55], s82 offen lds
    s_add_u32 m0, s79, 38912
    s_add_u32 s82, s81, 98368
    buffer_load_dwordx4 v2, s[52:55], s82 offen lds
    s_add_u32 m0, s79, 40960
    s_add_u32 s82, s81, 98432
    buffer_load_dwordx4 v2, s[52:55], s82 offen lds
    s_add_u32 m0, s79, 37888
    s_add_u32 s82, s81, 147456
    buffer_load_dwordx4 v2, s[52:55], s82 offen lds
    s_add_u32 m0, s79, 39936
    s_add_u32 s82, s81, 147520
    buffer_load_dwordx4 v2, s[52:55], s82 offen lds
    s_add_u32 m0, s79, 41984
    s_add_u32 s82, s81, 147584
    buffer_load_dwordx4 v2, s[52:55], s82 offen lds
    s_waitcnt vmcnt(24)
    s_barrier
    s_add_u32 s80, s8, 6
    s_cmp_ge_u32 s80, 10
    s_cselect_b32 s15, 10, 0
    s_sub_u32 s80, s80, s15
    s_mul_i32 s81, s80, 196608
    s_add_u32 m0, s79, 0
    s_add_u32 s82, s81, 0
    buffer_load_dwordx4 v2, s[52:55], s82 offen lds
    s_add_u32 m0, s79, 2048
    s_add_u32 s82, s81, 64
    buffer_load_dwordx4 v2, s[52:55], s82 offen lds
    s_add_u32 m0, s79, 4096
    s_add_u32 s82, s81, 128
    buffer_load_dwordx4 v2, s[52:55], s82 offen lds
    s_add_u32 m0, s79, 1024
    s_add_u32 s82, s81, 49152
    buffer_load_dwordx4 v2, s[52:55], s82 offen lds
    s_add_u32 m0, s79, 3072
    s_add_u32 s82, s81, 49216
    buffer_load_dwordx4 v2, s[52:55], s82 offen lds
    s_add_u32 m0, s79, 5120
    s_add_u32 s82, s81, 49280
    buffer_load_dwordx4 v2, s[52:55], s82 offen lds
    s_waitcnt vmcnt(12)
    s_barrier
    s_add_u32 s80, s8, 6
    s_cmp_ge_u32 s80, 10
    s_cselect_b32 s15, 10, 0
    s_sub_u32 s80, s80, s15
    s_lshl_b32 s81, s80, 7
    s_add_u32 m0, s78, 0
    s_add_u32 s82, s81, 0
    buffer_load_dwordx4 v3, s[48:51], s82 offen lds
    s_add_u32 m0, s78, 8192
    s_add_u32 s82, s81, 64
    buffer_load_dwordx4 v3, s[48:51], s82 offen lds
    s_add_u32 m0, s78, 2048
    s_add_u32 s82, s81, 40960
    buffer_load_dwordx4 v3, s[48:51], s82 offen lds
    s_add_u32 m0, s78, 10240
    s_add_u32 s82, s81, 41024
    buffer_load_dwordx4 v3, s[48:51], s82 offen lds
    s_add_u32 m0, s78, 4096
    s_add_u32 s82, s81, 81920
    buffer_load_dwordx4 v3, s[48:51], s82 offen lds
    s_add_u32 m0, s78, 12288
    s_add_u32 s82, s81, 81984
    buffer_load_dwordx4 v3, s[48:51], s82 offen lds
    s_add_u32 m0, s78, 6144
    s_add_u32 s82, s81, 122880
    buffer_load_dwordx4 v3, s[48:51], s82 offen lds
    s_add_u32 m0, s78, 14336
    s_add_u32 s82, s81, 122944
    buffer_load_dwordx4 v3, s[48:51], s82 offen lds
    s_add_u32 s80, s8, 6
    s_cmp_ge_u32 s80, 10
    s_cselect_b32 s15, 10, 0
    s_sub_u32 s80, s80, s15
    s_mul_i32 s81, s80, 196608
    s_add_u32 m0, s79, 12288
    s_add_u32 s82, s81, 98304
    buffer_load_dwordx4 v2, s[52:55], s82 offen lds
    s_add_u32 m0, s79, 14336
    s_add_u32 s82, s81, 98368
    buffer_load_dwordx4 v2, s[52:55], s82 offen lds
    s_add_u32 m0, s79, 16384
    s_add_u32 s82, s81, 98432
    buffer_load_dwordx4 v2, s[52:55], s82 offen lds
    s_add_u32 m0, s79, 13312
    s_add_u32 s82, s81, 147456
    buffer_load_dwordx4 v2, s[52:55], s82 offen lds
    s_add_u32 m0, s79, 15360
    s_add_u32 s82, s81, 147520
    buffer_load_dwordx4 v2, s[52:55], s82 offen lds
    s_add_u32 m0, s79, 17408
    s_add_u32 s82, s81, 147584
    buffer_load_dwordx4 v2, s[52:55], s82 offen lds
    s_waitcnt vmcnt(20)
    s_barrier
    s_add_u32 s80, s8, 7
    s_cmp_ge_u32 s80, 10
    s_cselect_b32 s15, 10, 0
    s_sub_u32 s80, s80, s15
    s_mul_i32 s81, s80, 196608
    s_add_u32 m0, s79, 24576
    s_add_u32 s82, s81, 0
    buffer_load_dwordx4 v2, s[52:55], s82 offen lds
    s_add_u32 m0, s79, 26624
    s_add_u32 s82, s81, 64
    buffer_load_dwordx4 v2, s[52:55], s82 offen lds
    s_add_u32 m0, s79, 28672
    s_add_u32 s82, s81, 128
    buffer_load_dwordx4 v2, s[52:55], s82 offen lds
    s_add_u32 m0, s79, 25600
    s_add_u32 s82, s81, 49152
    buffer_load_dwordx4 v2, s[52:55], s82 offen lds
    s_add_u32 m0, s79, 27648
    s_add_u32 s82, s81, 49216
    buffer_load_dwordx4 v2, s[52:55], s82 offen lds
    s_add_u32 m0, s79, 29696
    s_add_u32 s82, s81, 49280
    buffer_load_dwordx4 v2, s[52:55], s82 offen lds
    s_waitcnt vmcnt(12)
    s_barrier
    s_add_u32 s80, s8, 7
    s_cmp_ge_u32 s80, 10
    s_cselect_b32 s15, 10, 0
    s_sub_u32 s80, s80, s15
    s_lshl_b32 s81, s80, 7
    s_add_u32 m0, s78, 16384
    s_add_u32 s82, s81, 0
    buffer_load_dwordx4 v3, s[48:51], s82 offen lds
    s_add_u32 m0, s78, 24576
    s_add_u32 s82, s81, 64
    buffer_load_dwordx4 v3, s[48:51], s82 offen lds
    s_add_u32 m0, s78, 18432
    s_add_u32 s82, s81, 40960
    buffer_load_dwordx4 v3, s[48:51], s82 offen lds
    s_add_u32 m0, s78, 26624
    s_add_u32 s82, s81, 41024
    buffer_load_dwordx4 v3, s[48:51], s82 offen lds
    s_add_u32 m0, s78, 20480
    s_add_u32 s82, s81, 81920
    buffer_load_dwordx4 v3, s[48:51], s82 offen lds
    s_add_u32 m0, s78, 28672
    s_add_u32 s82, s81, 81984
    buffer_load_dwordx4 v3, s[48:51], s82 offen lds
    s_add_u32 m0, s78, 22528
    s_add_u32 s82, s81, 122880
    buffer_load_dwordx4 v3, s[48:51], s82 offen lds
    s_add_u32 m0, s78, 30720
    s_add_u32 s82, s81, 122944
    buffer_load_dwordx4 v3, s[48:51], s82 offen lds
    s_add_u32 s80, s8, 7
    s_cmp_ge_u32 s80, 10
    s_cselect_b32 s15, 10, 0
    s_sub_u32 s80, s80, s15
    s_mul_i32 s81, s80, 196608
    s_add_u32 m0, s79, 36864
    s_add_u32 s82, s81, 98304
    buffer_load_dwordx4 v2, s[52:55], s82 offen lds
    s_add_u32 m0, s79, 38912
    s_add_u32 s82, s81, 98368
    buffer_load_dwordx4 v2, s[52:55], s82 offen lds
    s_add_u32 m0, s79, 40960
    s_add_u32 s82, s81, 98432
    buffer_load_dwordx4 v2, s[52:55], s82 offen lds
    s_add_u32 m0, s79, 37888
    s_add_u32 s82, s81, 147456
    buffer_load_dwordx4 v2, s[52:55], s82 offen lds
    s_add_u32 m0, s79, 39936
    s_add_u32 s82, s81, 147520
    buffer_load_dwordx4 v2, s[52:55], s82 offen lds
    s_add_u32 m0, s79, 41984
    s_add_u32 s82, s81, 147584
    buffer_load_dwordx4 v2, s[52:55], s82 offen lds
    s_waitcnt vmcnt(20)
    s_barrier
    s_add_u32 s80, s8, 8
    s_cmp_ge_u32 s80, 10
    s_cselect_b32 s15, 10, 0
    s_sub_u32 s80, s80, s15
    s_mul_i32 s81, s80, 196608
    s_add_u32 m0, s79, 0
    s_add_u32 s82, s81, 0
    buffer_load_dwordx4 v2, s[52:55], s82 offen lds
    s_add_u32 m0, s79, 2048
    s_add_u32 s82, s81, 64
    buffer_load_dwordx4 v2, s[52:55], s82 offen lds
    s_add_u32 m0, s79, 4096
    s_add_u32 s82, s81, 128
    buffer_load_dwordx4 v2, s[52:55], s82 offen lds
    s_add_u32 m0, s79, 1024
    s_add_u32 s82, s81, 49152
    buffer_load_dwordx4 v2, s[52:55], s82 offen lds
    s_add_u32 m0, s79, 3072
    s_add_u32 s82, s81, 49216
    buffer_load_dwordx4 v2, s[52:55], s82 offen lds
    s_add_u32 m0, s79, 5120
    s_add_u32 s82, s81, 49280
    buffer_load_dwordx4 v2, s[52:55], s82 offen lds
    s_waitcnt vmcnt(12)
    s_barrier
    s_add_u32 s80, s8, 8
    s_cmp_ge_u32 s80, 10
    s_cselect_b32 s15, 10, 0
    s_sub_u32 s80, s80, s15
    s_lshl_b32 s81, s80, 7
    s_add_u32 m0, s78, 0
    s_add_u32 s82, s81, 0
    buffer_load_dwordx4 v3, s[48:51], s82 offen lds
    s_add_u32 m0, s78, 8192
    s_add_u32 s82, s81, 64
    buffer_load_dwordx4 v3, s[48:51], s82 offen lds
    s_add_u32 m0, s78, 2048
    s_add_u32 s82, s81, 40960
    buffer_load_dwordx4 v3, s[48:51], s82 offen lds
    s_add_u32 m0, s78, 10240
    s_add_u32 s82, s81, 41024
    buffer_load_dwordx4 v3, s[48:51], s82 offen lds
    s_add_u32 m0, s78, 4096
    s_add_u32 s82, s81, 81920
    buffer_load_dwordx4 v3, s[48:51], s82 offen lds
    s_add_u32 m0, s78, 12288
    s_add_u32 s82, s81, 81984
    buffer_load_dwordx4 v3, s[48:51], s82 offen lds
    s_add_u32 m0, s78, 6144
    s_add_u32 s82, s81, 122880
    buffer_load_dwordx4 v3, s[48:51], s82 offen lds
    s_add_u32 m0, s78, 14336
    s_add_u32 s82, s81, 122944
    buffer_load_dwordx4 v3, s[48:51], s82 offen lds
    s_add_u32 s80, s8, 8
    s_cmp_ge_u32 s80, 10
    s_cselect_b32 s15, 10, 0
    s_sub_u32 s80, s80, s15
    s_mul_i32 s81, s80, 196608
    s_add_u32 m0, s79, 12288
    s_add_u32 s82, s81, 98304
    buffer_load_dwordx4 v2, s[52:55], s82 offen lds
    s_add_u32 m0, s79, 14336
    s_add_u32 s82, s81, 98368
    buffer_load_dwordx4 v2, s[52:55], s82 offen lds
    s_add_u32 m0, s79, 16384
    s_add_u32 s82, s81, 98432
    buffer_load_dwordx4 v2, s[52:55], s82 offen lds
    s_add_u32 m0, s79, 13312
    s_add_u32 s82, s81, 147456
    buffer_load_dwordx4 v2, s[52:55], s82 offen lds
    s_add_u32 m0, s79, 15360
    s_add_u32 s82, s81, 147520
    buffer_load_dwordx4 v2, s[52:55], s82 offen lds
    s_add_u32 m0, s79, 17408
    s_add_u32 s82, s81, 147584
    buffer_load_dwordx4 v2, s[52:55], s82 offen lds
    s_waitcnt vmcnt(20)
    s_barrier
    s_add_u32 s80, s8, 9
    s_cmp_ge_u32 s80, 10
    s_cselect_b32 s15, 10, 0
    s_sub_u32 s80, s80, s15
    s_mul_i32 s81, s80, 196608
    s_add_u32 m0, s79, 24576
    s_add_u32 s82, s81, 0
    buffer_load_dwordx4 v2, s[52:55], s82 offen lds
    s_add_u32 m0, s79, 26624
    s_add_u32 s82, s81, 64
    buffer_load_dwordx4 v2, s[52:55], s82 offen lds
    s_add_u32 m0, s79, 28672
    s_add_u32 s82, s81, 128
    buffer_load_dwordx4 v2, s[52:55], s82 offen lds
    s_add_u32 m0, s79, 25600
    s_add_u32 s82, s81, 49152
    buffer_load_dwordx4 v2, s[52:55], s82 offen lds
    s_add_u32 m0, s79, 27648
    s_add_u32 s82, s81, 49216
    buffer_load_dwordx4 v2, s[52:55], s82 offen lds
    s_add_u32 m0, s79, 29696
    s_add_u32 s82, s81, 49280
    buffer_load_dwordx4 v2, s[52:55], s82 offen lds
    s_waitcnt vmcnt(12)
    s_barrier
    s_add_u32 s80, s8, 9
    s_cmp_ge_u32 s80, 10
    s_cselect_b32 s15, 10, 0
    s_sub_u32 s80, s80, s15
    s_lshl_b32 s81, s80, 7
    s_add_u32 m0, s78, 16384
    s_add_u32 s82, s81, 0
    buffer_load_dwordx4 v3, s[48:51], s82 offen lds
    s_add_u32 m0, s78, 24576
    s_add_u32 s82, s81, 64
    buffer_load_dwordx4 v3, s[48:51], s82 offen lds
    s_add_u32 m0, s78, 18432
    s_add_u32 s82, s81, 40960
    buffer_load_dwordx4 v3, s[48:51], s82 offen lds
    s_add_u32 m0, s78, 26624
    s_add_u32 s82, s81, 41024
    buffer_load_dwordx4 v3, s[48:51], s82 offen lds
    s_add_u32 m0, s78, 20480
    s_add_u32 s82, s81, 81920
    buffer_load_dwordx4 v3, s[48:51], s82 offen lds
    s_add_u32 m0, s78, 28672
    s_add_u32 s82, s81, 81984
    buffer_load_dwordx4 v3, s[48:51], s82 offen lds
    s_add_u32 m0, s78, 22528
    s_add_u32 s82, s81, 122880
    buffer_load_dwordx4 v3, s[48:51], s82 offen lds
    s_add_u32 m0, s78, 30720
    s_add_u32 s82, s81, 122944
    buffer_load_dwordx4 v3, s[48:51], s82 offen lds
    s_add_u32 s80, s8, 9
    s_cmp_ge_u32 s80, 10
    s_cselect_b32 s15, 10, 0
    s_sub_u32 s80, s80, s15
    s_mul_i32 s81, s80, 196608
    s_add_u32 m0, s79, 36864
    s_add_u32 s82, s81, 98304
    buffer_load_dwordx4 v2, s[52:55], s82 offen lds
    s_add_u32 m0, s79, 38912
    s_add_u32 s82, s81, 98368
    buffer_load_dwordx4 v2, s[52:55], s82 offen lds
    s_add_u32 m0, s79, 40960
    s_add_u32 s82, s81, 98432
    buffer_load_dwordx4 v2, s[52:55], s82 offen lds
    s_add_u32 m0, s79, 37888
    s_add_u32 s82, s81, 147456
    buffer_load_dwordx4 v2, s[52:55], s82 offen lds
    s_add_u32 m0, s79, 39936
    s_add_u32 s82, s81, 147520
    buffer_load_dwordx4 v2, s[52:55], s82 offen lds
    s_add_u32 m0, s79, 41984
    s_add_u32 s82, s81, 147584
    buffer_load_dwordx4 v2, s[52:55], s82 offen lds
    s_mov_b32 s83, s74
    s_branch L_Yt
L_C:
    s_setprio 2
    s_sub_u32 s78, s3, 6
    s_mul_i32 s79, s78, 17728
    s_add_u32 s79, s79, 81920
    s_add_u32 s84, s79, 35456
    s_mul_i32 s93, s78, 4800
    s_add_u32 s93, s93, 99648
    s_and_b32 s85, s10, 1
    s_lshl_b32 s85, s85, 5
    s_mul_i32 s80, s10, 160
    s_sub_u32 s80, s80, s85
    s_lshl_b32 s81, s9, 6
    s_lshl_b32 s74, s78, 5
    s_add_u32 s81, s81, s74
    v_mul_u32_u24 v4, 5462, v1
    v_lshrrev_b32 v4, 16, v4
    v_mul_u32_u24 v5, 12, v4
    v_sub_u32 v5, v1, v5
    v_mul_u32_u24 v6, 1280, v4
    v_lshl_add_u32 v6, v5, 4, v6
    v_add_u32 v6, s80, v6
    s_mul_i32 s74, s9, 48
    s_mul_i32 s75, s78, 24
    s_add_u32 s74, s74, s75
    s_mul_i32 s74, s74, 1280
    v_add_u32 v16, s74, v6
    v_add_u32 v17, 6400, v16
    s_mul_i32 s74, s81, 1280
    v_add_u32 v20, s74, v6
    v_add_u32 v21, 6400, v20
    v_subrev_u32 v18, 3840, v20
    v_add_u32 v19, 6400, v18
    s_waitcnt lgkmcnt(0)
    s_mov_b32 s44, s42
    s_and_b32 s45, s43, 0xffff
    s_mov_b32 s46, 268435456
    s_mov_b32 s47, 0x20000
    s_mov_b32 s64, s40
    s_and_b32 s65, s41, 0xffff
    s_mov_b32 s66, 256
    s_mov_b32 s67, 0x20000
    s_cmp_lg_u32 s2, 0
    s_cbranch_scc1 L_noep_1
    s_cmp_lg_u32 s78, 0
    s_cbranch_scc1 L_noep_1
    s_memrealtime s[74:75]
    s_waitcnt lgkmcnt(0)
    s_or_b32 s75, s75, 0x40000000
    v_mov_b32 v8, s74
    v_mov_b32 v9, s75
    v_mov_b32 v10, 0
    s_mov_b64 exec, 1
    buffer_store_dwordx2 v[8:9], v10, s[64:67], 0 offen sc1
    s_mov_b64 exec, -1
L_noep_1:
    s_mov_b32 s48, s18
    s_and_b32 s49, s19, 0xffff
    s_mov_b32 s50, 2621440
    s_mov_b32 s51, 0x20000
    s_mov_b32 s52, s20
    s_and_b32 s53, s21, 0xffff
    s_mov_b32 s54, 2621440
    s_mov_b32 s55, 0x20000
    s_mov_b32 s56, s22
    s_and_b32 s57, s23, 0xffff
    s_mov_b32 s58, 5120
    s_mov_b32 s59, 0x20000
    s_mov_b32 s60, s24
    s_and_b32 s61, s25, 0xffff
    s_mov_b32 s62, 2621440
    s_mov_b32 s63, 0x20000
    s_mov_b32 s68, s16
    s_and_b32 s69, s17, 0xffff
    s_mov_b32 s70, 2621440
    s_mov_b32 s71, 0x20000
    s_mov_b32 s88, s34
    s_and_b32 s89, s35, 0xffff
    s_mov_b32 s90, 1966080
    s_mov_b32 s91, 0x20000
    v_mov_b32 v23, 0
    v_mov_b32 v37, 1
    v_mov_b32 v37, s2
    s_barrier
    s_add_u32 m0, s84, 0
    s_mov_b32 exec_lo, -1
    s_mov_b32 exec_hi, 0xfffffff
    buffer_load_dwordx4 v18, s[48:51], 0 offen  lds
    s_add_u32 m0, s84, 960
    s_mov_b32 s77, 0
    buffer_load_dwordx4 v19, s[48:51], s77 offen  lds
    s_add_u32 m0, s84, 1920
    s_mov_b32 s77, 6400
    buffer_load_dwordx4 v19, s[48:51], s77 offen  lds
    s_add_u32 m0, s84, 2880
    s_mov_b32 s77, 12800
    buffer_load_dwordx4 v19, s[48:51], s77 offen  lds
    s_add_u32 m0, s84, 3840
    s_mov_b32 s77, 19200
    buffer_load_dwordx4 v19, s[48:51], s77 offen  lds
    s_add_u32 m0, s84, 4800
    s_mov_b32 s77, 25600
    buffer_load_dwordx4 v19, s[48:51], s77 offen  lds
    s_add_u32 m0, s84, 5760
    s_mov_b32 s77, 32000
    buffer_load_dwordx4 v19, s[48:51], s77 offen  lds
    s_mov_b64 exec, -1
    s_add_u32 m0, s84, 6720
    s_mov_b32 exec_lo, -1
    s_mov_b32 exec_hi, 0xfffffff
    buffer_load_dwordx4 v20, s[52:55], 0 offen  lds
    s_add_u32 m0, s84, 7680
    s_mov_b32 s77, 0
    buffer_load_dwordx4 v21, s[52:55], s77 offen  lds
    s_add_u32 m0, s84, 8640
    s_mov_b32 s77, 6400
    buffer_load_dwordx4 v21, s[52:55], s77 offen  lds
    s_add_u32 m0, s84, 9600
    s_mov_b32 s77, 12800
    buffer_load_dwordx4 v21, s[52:55], s77 offen  lds
    s_add_u32 m0, s84, 10560
    s_mov_b32 s77, 19200
    buffer_load_dwordx4 v21, s[52:55], s77 offen  lds
    s_add_u32 m0, s84, 11520
    s_mov_b32 s77, 25600
    buffer_load_dwordx4 v21, s[52:55], s77 offen  lds
    s_add_u32 m0, s84, 12480
    s_mov_b32 exec_lo, 0xffffff
    s_mov_b32 exec_hi, 0
    s_mov_b32 s77, 32000
    buffer_load_dwordx4 v21, s[52:55], s77 offen  lds
    s_mov_b64 exec, -1
    s_mul_i32 s75, s10, 640
    s_add_u32 m0, s84, 13440
    s_mov_b32 exec_lo, -1
    s_mov_b32 exec_hi, 0xff
    buffer_load_dwordx4 v12, s[56:59], s75 offen lds
    s_mov_b64 exec, -1
    buffer_load_dwordx2 v[38:39], v23, s[64:67], 0 offen sc1
    s_barrier
    s_mov_b32 s76, 0x986431
    s_bitcmp1_b32 s11, 0
    s_cselect_b32 s76, 0x975420, s76
    v_lshrrev_b32 v240, 4, v1
    v_lshlrev_b32 v240, 2, v240
    v_lshrrev_b32_e64 v241, v240, s76
    v_and_b32 v241, 15, v241
    s_lshr_b32 s76, s76, 16
    v_lshrrev_b32_e64 v242, v240, s76
    v_and_b32 v242, 15, v242
    v_and_b32 v243, 15, v1
    v_mul_u32_u24 v243, 1280, v243
    v_lshl_add_u32 v241, v241, 7, v243
    v_lshl_add_u32 v242, v242, 7, v243
    s_lshl_b32 s76, s6, 3
    s_lshl_b32 s77, s12, 1
    s_add_u32 s76, s76, s77
    s_add_u32 s76, s76, s78
    s_mul_i32 s98, s76, 20480
    v_bfe_u32 v243, v1, 4, 1
    v_mul_u32_u24 v243, 983040, v243
    v_bfe_u32 v244, v1, 1, 3
    v_mul_u32_u24 v244, 3072, v244
    v_add_u32 v243, v243, v244
    v_and_b32 v244, 1, v1
    v_lshl_add_u32 v243, v244, 7, v243
    s_mul_i32 s76, s7, 192
    s_and_b32 s76, s76, 0xffffff80
    s_mul_i32 s77, s11, 24576
    s_add_u32 s76, s76, s77
    s_add_u32 s99, s76, 786432
    s_cmp_eq_u32 s78, 0
    s_cselect_b32 s48, s30, s32
    s_cselect_b32 s49, s31, s33
    s_and_b32 s49, s49, 0xffff
    s_mov_b32 s50, 1966080
    s_mov_b32 s51, 0x20000
    s_barrier
    s_mov_b32 exec_hi, 0
    buffer_load_dword v250, v243, s[48:51], s99 offen
    s_mov_b64 exec, -1
    s_add_u32 m0, s93, 0
    s_mov_b32 exec_lo, -1
    s_mov_b32 exec_hi, 0xfffffff
    buffer_load_dwordx4 v16, s[88:91], 0 offen  lds
    s_add_u32 m0, s93, 960
    s_mov_b32 s77, 0
    buffer_load_dwordx4 v17, s[88:91], s77 offen  lds
    s_add_u32 m0, s93, 1920
    s_mov_b32 s77, 6400
    buffer_load_dwordx4 v17, s[88:91], s77 offen  lds
    s_add_u32 m0, s93, 2880
    s_mov_b32 s77, 12800
    buffer_load_dwordx4 v17, s[88:91], s77 offen  lds
    s_add_u32 m0, s93, 3840
    s_mov_b32 exec_lo, -1
    s_mov_b32 exec_hi, 0xffff
    s_mov_b32 s77, 19200
    buffer_load_dwordx4 v17, s[88:91], s77 offen  lds
    s_mov_b64 exec, -1
    s_lshr_b32 s74, s85, 4
    v_subrev_u32 v7, s74, v5
    v_cmp_gt_u32 s[86:87], 10, v7
    v_cmp_gt_u32 vcc, 60, v1
    s_and_b64 s[86:87], s[86:87], vcc
    v_mul_u32_u24 v22, 160, v4
    v_lshl_add_u32 v22, v7, 4, v22
    s_mul_i32 s76, s78, 5120
    s_add_u32 s76, s76, 152832
    v_add_u32 v22, s76, v22
    s_lshl_b32 s75, s9, 6
    s_lshl_b32 s76, s10, 3
    s_add_u32 s75, s75, s76
    s_lshl_b32 s76, s78, 2
    s_add_u32 s82, s75, s76
    v_lshrrev_b32 v14, 4, v1
    v_mul_u32_u24 v14, 1280, v14
    v_and_b32 v15, 15, v1
    v_lshlrev_b32 v15, 4, v15
    v_add_u32 v14, v14, v15
    v_and_b32 v240, 15, v1
    v_lshrrev_b32 v241, 4, v1
    v_lshrrev_b32 v242, 2, v240
    v_mul_u32_u24 v242, 192, v242
    v_and_b32 v243, 3, v240
    v_lshl_add_u32 v242, v243, 3, v242
    v_add_u32 v242, s93, v242
    v_add_u32 v242, s85, v242
    s_mul_i32 s74, s9, 6
    s_mul_i32 s75, s78, 3
    s_add_u32 s74, s74, s75
    v_add_u32 v243, 0, v241
    v_mul_u32_u24 v244, 52, v243
    v_lshrrev_b32 v244, 8, v244
    v_mul_u32_u24 v245, 5, v244
    v_sub_u32 v245, v243, v245
    v_mul_u32_u24 v24, 1536, v244
    v_lshl_add_u32 v24, v245, 5, v24
    v_add_u32 v24, v24, v242
    v_add_u32 v244, s74, v244
    v_lshrrev_b32 v247, 2, v244
    v_mul_u32_u24 v28, 5120, v247
    v_and_b32 v244, 3, v244
    v_lshl_add_u32 v28, v244, 8, v28
    v_lshl_add_u32 v28, v245, 10, v28
    v_lshl_add_u32 v28, v240, 4, v28
    v_add_u32 v243, 4, v241
    v_mul_u32_u24 v244, 52, v243
    v_lshrrev_b32 v244, 8, v244
    v_mul_u32_u24 v245, 5, v244
    v_sub_u32 v245, v243, v245
    v_mul_u32_u24 v25, 1536, v244
    v_lshl_add_u32 v25, v245, 5, v25
    v_add_u32 v25, v25, v242
    v_add_u32 v244, s74, v244
    v_lshrrev_b32 v247, 2, v244
    v_mul_u32_u24 v29, 5120, v247
    v_and_b32 v244, 3, v244
    v_lshl_add_u32 v29, v244, 8, v29
    v_lshl_add_u32 v29, v245, 10, v29
    v_lshl_add_u32 v29, v240, 4, v29
    v_add_u32 v243, 8, v241
    v_mul_u32_u24 v244, 52, v243
    v_lshrrev_b32 v244, 8, v244
    v_mul_u32_u24 v245, 5, v244
    v_sub_u32 v245, v243, v245
    v_mul_u32_u24 v26, 1536, v244
    v_lshl_add_u32 v26, v245, 5, v26
    v_add_u32 v26, v26, v242
    v_add_u32 v244, s74, v244
    v_lshrrev_b32 v247, 2, v244
    v_mul_u32_u24 v30, 5120, v247
    v_and_b32 v244, 3, v244
    v_lshl_add_u32 v30, v244, 8, v30
    v_lshl_add_u32 v30, v245, 10, v30
    v_lshl_add_u32 v30, v240, 4, v30
    v_add_u32 v243, 12, v241
    v_mul_u32_u24 v244, 52, v243
    v_lshrrev_b32 v244, 8, v244
    v_mul_u32_u24 v245, 5, v244
    v_sub_u32 v245, v243, v245
    v_mul_u32_u24 v27, 1536, v244
    v_lshl_add_u32 v27, v245, 5, v27
    v_add_u32 v27, v27, v242
    v_add_u32 v244, s74, v244
    v_lshrrev_b32 v247, 2, v244
    v_mul_u32_u24 v31, 5120, v247
    v_and_b32 v244, 3, v244
    v_lshl_add_u32 v31, v244, 8, v31
    v_lshl_add_u32 v31, v245, 10, v31
    v_lshl_add_u32 v31, v240, 4, v31
    v_lshrrev_b32 v6, 3, v1
    v_and_b32 v7, 7, v1
    s_mul_i32 s74, s78, 40
    v_add_u32 v6, s74, v6
    v_add_u32 v8, 0, v6
    v_mul_u32_u24 v9, 3277, v8
    v_lshrrev_b32 v9, 16, v9
    v_mul_u32_u24 v10, 20, v9
    v_sub_u32 v8, v8, v10
    v_lshl_add_u32 v9, v8, 2, v9
    v_xor_b32 v8, v8, v7
    v_and_b32 v8, 7, v8
    v_lshlrev_b32 v8, 4, v8
    v_mul_u32_u24 v9, 4224, v9
    v_add_u32 v32, v9, v8
    v_add_u32 v8, 8, v6
    v_mul_u32_u24 v9, 3277, v8
    v_lshrrev_b32 v9, 16, v9
    v_mul_u32_u24 v10, 20, v9
    v_sub_u32 v8, v8, v10
    v_lshl_add_u32 v9, v8, 2, v9
    v_xor_b32 v8, v8, v7
    v_and_b32 v8, 7, v8
    v_lshlrev_b32 v8, 4, v8
    v_mul_u32_u24 v9, 4224, v9
    v_add_u32 v33, v9, v8
    v_add_u32 v8, 16, v6
    v_mul_u32_u24 v9, 3277, v8
    v_lshrrev_b32 v9, 16, v9
    v_mul_u32_u24 v10, 20, v9
    v_sub_u32 v8, v8, v10
    v_lshl_add_u32 v9, v8, 2, v9
    v_xor_b32 v8, v8, v7
    v_and_b32 v8, 7, v8
    v_lshlrev_b32 v8, 4, v8
    v_mul_u32_u24 v9, 4224, v9
    v_add_u32 v34, v9, v8
    v_add_u32 v8, 24, v6
    v_mul_u32_u24 v9, 3277, v8
    v_lshrrev_b32 v9, 16, v9
    v_mul_u32_u24 v10, 20, v9
    v_sub_u32 v8, v8, v10
    v_lshl_add_u32 v9, v8, 2, v9
    v_xor_b32 v8, v8, v7
    v_and_b32 v8, 7, v8
    v_lshlrev_b32 v8, 4, v8
    v_mul_u32_u24 v9, 4224, v9
    v_add_u32 v35, v9, v8
    v_add_u32 v8, 32, v6
    v_mul_u32_u24 v9, 3277, v8
    v_lshrrev_b32 v9, 16, v9
    v_mul_u32_u24 v10, 20, v9
    v_sub_u32 v8, v8, v10
    v_lshl_add_u32 v9, v8, 2, v9
    v_xor_b32 v8, v8, v7
    v_and_b32 v8, 7, v8
    v_lshlrev_b32 v8, 4, v8
    v_mul_u32_u24 v9, 4224, v9
    v_add_u32 v36, v9, v8
    v_mov_b32 v23, 0
    s_mul_i32 s75, s82, 1280
    buffer_load_dwordx4 v[124:127], v14, s[68:71], s75 offen offset:0
    s_mul_i32 s75, s82, 1280
    buffer_load_dwordx4 v[128:131], v14, s[68:71], s75 offen offset:256
    s_mul_i32 s75, s82, 1280
    buffer_load_dwordx4 v[132:135], v14, s[68:71], s75 offen offset:512
    s_mul_i32 s75, s82, 1280
    buffer_load_dwordx4 v[136:139], v14, s[68:71], s75 offen offset:768
    s_mul_i32 s75, s82, 1280
    buffer_load_dwordx4 v[140:143], v14, s[68:71], s75 offen offset:1024
    s_mov_b32 s56, s36
    s_and_b32 s57, s37, 0xffff
    s_mov_b32 s58, 1280
    s_mov_b32 s59, 0x20000
    buffer_load_dwordx4 v[144:147], v15, s[56:59], 0 offen offset:0
    buffer_load_dwordx4 v[148:151], v15, s[56:59], 0 offen offset:256
    buffer_load_dwordx4 v[152:155], v15, s[56:59], 0 offen offset:512
    buffer_load_dwordx4 v[156:159], v15, s[56:59], 0 offen offset:768
    buffer_load_dwordx4 v[160:163], v15, s[56:59], 0 offen offset:1024
    s_waitcnt vmcnt(17)
    s_barrier
    s_waitcnt vmcnt(16)
    s_mov_b32 s94, 30000
L_ep_2:
    v_readfirstlane_b32 s72, v38
    v_readfirstlane_b32 s73, v39
    s_nop 1
    s_cmp_lg_u32 s73, 0
    s_cbranch_scc1 L_epd_3
    buffer_load_dwordx2 v[38:39], v23, s[64:67], 0 offen sc1
    s_waitcnt vmcnt(0)
    s_sub_u32 s94, s94, 1
    s_cbranch_scc0 L_ep_2
L_epd_3:
    v_mov_b32 v242, 163104
    ds_write_b64 v242, v[38:39]
    s_cmp_eq_u32 s78, 0
    s_cbranch_scc1 L_tk_4
    s_mov_b64 exec, 1
    ds_write_b32 v242, v37 offset:16
    s_mov_b64 exec, -1
L_tk_4:
    s_barrier
    s_waitcnt vmcnt(0)
    v_mov_b32 v240, 0
    v_mov_b32 v241, 0
    v_dot2_f32_bf16 v240, v124, v144, v240
    v_dot2_f32_bf16 v241, v125, v145, v241
    v_dot2_f32_bf16 v240, v126, v146, v240
    v_dot2_f32_bf16 v241, v127, v147, v241
    v_dot2_f32_bf16 v240, v128, v148, v240
    v_dot2_f32_bf16 v241, v129, v149, v241
    v_dot2_f32_bf16 v240, v130, v150, v240
    v_dot2_f32_bf16 v241, v131, v151, v241
    v_dot2_f32_bf16 v240, v132, v152, v240
    v_dot2_f32_bf16 v241, v133, v153, v241
    v_dot2_f32_bf16 v240, v134, v154, v240
    v_dot2_f32_bf16 v241, v135, v155, v241
    v_dot2_f32_bf16 v240, v136, v156, v240
    v_dot2_f32_bf16 v241, v137, v157, v241
    v_dot2_f32_bf16 v240, v138, v158, v240
    v_dot2_f32_bf16 v241, v139, v159, v241
    v_dot2_f32_bf16 v240, v140, v160, v240
    v_dot2_f32_bf16 v241, v141, v161, v241
    v_dot2_f32_bf16 v240, v142, v162, v240
    v_dot2_f32_bf16 v241, v143, v163, v241
    s_barrier
    s_mul_i32 s74, s78, 5120
    s_add_u32 s74, s74, 81920
    v_add_u32 v13, s74, v12
    ds_read_b128 v[40:43], v13 offset:0
    ds_read_b128 v[44:47], v13 offset:1024
    ds_read_b128 v[48:51], v13 offset:2048
    ds_read_b128 v[52:55], v13 offset:3072
    ds_read_b128 v[56:59], v13 offset:4096
    s_waitcnt lgkmcnt(0)
    s_mul_i32 s74, s10, 337920
    s_lshl_b32 s75, s9, 7
    s_sub_u32 s74, s74, s75
    s_add_u32 s74, s74, 8392576
    buffer_store_dwordx4 v[40:43], v32, s[44:47], s74 offen sc1
    buffer_store_dwordx4 v[44:47], v33, s[44:47], s74 offen sc1
    buffer_store_dwordx4 v[48:51], v34, s[44:47], s74 offen sc1
    buffer_store_dwordx4 v[52:55], v35, s[44:47], s74 offen sc1
    buffer_store_dwordx4 v[56:59], v36, s[44:47], s74 offen sc1
    s_barrier
    s_nop 2
    v_add_f32 v240, v240, v241
    s_nop 1
    v_add_f32_dpp v240, v240, v240 quad_perm:[1,0,3,2] row_mask:0xf bank_mask:0xf
    s_nop 1
    v_add_f32_dpp v240, v240, v240 quad_perm:[2,3,0,1] row_mask:0xf bank_mask:0xf
    s_nop 1
    v_add_f32_dpp v240, v240, v240 row_half_mirror row_mask:0xf bank_mask:0xf
    s_nop 1
    v_add_f32_dpp v240, v240, v240 row_mirror row_mask:0xf bank_mask:0xf
    s_nop 1
    v_cvt_pk_bf16_f32 v240, v240, v240
    v_and_b32 v240, 0xffff0000, v240
    v_mul_f32 v240, 0xbfb8aa3b, v240
    v_exp_f32 v240, v240
    s_nop 0
    v_add_f32 v240, 1.0, v240
    v_rcp_f32 v240, v240
    s_nop 0
    v_cvt_pk_bf16_f32 v240, v240, v240
    v_and_b32 v240, 0xffff0000, v240
    s_lshl_b32 s74, s82, 2
    s_add_u32 s74, s74, 14680064
    v_lshrrev_b32 v241, 4, v1
    v_lshlrev_b32 v241, 2, v241
    s_mov_b32 exec_lo, 0x00010001
    s_mov_b32 exec_hi, 0x00010001
    buffer_store_dword v240, v241, s[44:47], s74 offen sc1
    s_mov_b64 exec, -1
    ds_read_b64_tr_b16 v[96:97], v24
    ds_read_b64_tr_b16 v[98:99], v24 offset:768
    ds_read_b64_tr_b16 v[100:101], v25
    ds_read_b64_tr_b16 v[102:103], v25 offset:768
    ds_read_b64_tr_b16 v[104:105], v26
    ds_read_b64_tr_b16 v[106:107], v26 offset:768
    ds_read_b64_tr_b16 v[108:109], v27
    ds_read_b64_tr_b16 v[110:111], v27 offset:768
    s_mul_i32 s74, s10, 245888
    s_add_u32 s74, s74, 6356992
    s_waitcnt lgkmcnt(0)
    buffer_store_dwordx4 v[96:99], v28, s[44:47], s74 offen sc1
    buffer_store_dwordx4 v[100:103], v29, s[44:47], s74 offen sc1
    buffer_store_dwordx4 v[104:107], v30, s[44:47], s74 offen sc1
    s_mov_b32 exec_lo, -1
    s_mov_b32 exec_hi, 0xffff
    buffer_store_dwordx4 v[108:111], v31, s[44:47], s74 offen sc1
    s_mov_b64 exec, -1
    s_waitcnt lgkmcnt(0)
    s_barrier
    s_barrier
    s_barrier
    s_waitcnt vmcnt(0)
    s_lshl_b32 s74, s10, 9
    s_lshl_b32 s75, s9, 4
    s_add_u32 s74, s74, s75
    s_lshl_b32 s76, s78, 3
    s_add_u32 s74, s74, s76
    s_add_u32 s74, s74, 14745600
    v_mov_b32 v244, s72
    v_mov_b32 v245, s73
    v_mov_b32 v246, 0
    s_mov_b64 exec, 1
    buffer_store_dwordx2 v[244:245], v246, s[44:47], s74 offen sc1
    s_mov_b64 exec, -1
    s_lshl_b32 s76, s78, 3
    s_lshl_b32 s74, s9, 7
    s_lshl_b32 s75, s10, 4
    s_add_u32 s74, s74, s75
    s_add_u32 s74, s74, s76
    s_add_u32 s74, s74, 14753792
    v_mov_b32 v248, s72
    v_mov_b32 v249, s73
    v_mov_b32 v250, 0
    s_mov_b64 exec, 1
    buffer_store_dwordx2 v[248:249], v250, s[44:47], s74 offen sc1
    s_mov_b64 exec, -1
    s_add_u32 s83, s78, 2
    s_lshl_b32 s76, s14, 2
    s_add_u32 s76, s76, s83
    s_lshl_b32 s76, s76, 12
    buffer_load_dwordx4 v[164:167], v12, s[60:63], s76 offen offset:0
    buffer_load_dwordx4 v[168:171], v12, s[60:63], s76 offen offset:1024
    buffer_load_dwordx4 v[172:175], v12, s[60:63], s76 offen offset:2048
    buffer_load_dwordx4 v[176:179], v12, s[60:63], s76 offen offset:3072
    s_barrier
    s_barrier
    s_barrier
    s_barrier
    s_barrier
    s_barrier
    v_mov_b32 v2, 163120
    ds_read_b32 v2, v2
    s_waitcnt lgkmcnt(0)
    v_readfirstlane_b32 s14, v2
    s_nop 1
    s_mul_i32 s74, s14, 3277
    s_lshr_b32 s74, s74, 16
    s_min_u32 s74, s74, 7
    s_cmp_eq_u32 s78, 0
    s_cselect_b32 s74, s74, s10
    s_lshl_b32 s74, s74, 9
    s_add_u32 s74, s74, 14745600
    v_lshlrev_b32 v2, 3, v1
    buffer_load_dwordx2 v[4:5], v2, s[44:47], s74 offen sc1
    v_min_u32 v3, 15, v1
    v_lshlrev_b32 v3, 3, v3
    s_lshl_b32 s74, s9, 7
    s_add_u32 s74, s74, 14753792
    buffer_load_dwordx2 v[6:7], v3, s[44:47], s74 offen sc1
    s_barrier
    s_mov_b32 exec_lo, -1
    s_mov_b32 exec_hi, 0xfffffff
    buffer_load_dwordx4 v[196:199], v20, s[68:71], 0 offen
    s_mov_b64 exec, -1
    s_mov_b32 exec_lo, -1
    s_mov_b32 exec_hi, 0xfffffff
    s_mov_b32 s77, 0
    buffer_load_dwordx4 v[200:203], v21, s[68:71], s77 offen
    s_mov_b64 exec, -1
    s_mov_b32 exec_lo, -1
    s_mov_b32 exec_hi, 0xfffffff
    s_mov_b32 s77, 6400
    buffer_load_dwordx4 v[204:207], v21, s[68:71], s77 offen
    s_mov_b64 exec, -1
    s_mov_b32 exec_lo, -1
    s_mov_b32 exec_hi, 0xfffffff
    s_mov_b32 s77, 12800
    buffer_load_dwordx4 v[208:211], v21, s[68:71], s77 offen
    s_mov_b64 exec, -1
    s_mov_b32 exec_lo, -1
    s_mov_b32 exec_hi, 0xfffffff
    s_mov_b32 s77, 19200
    buffer_load_dwordx4 v[212:215], v21, s[68:71], s77 offen
    s_mov_b64 exec, -1
    s_mov_b32 exec_lo, -1
    s_mov_b32 exec_hi, 0xfffffff
    s_mov_b32 s77, 25600
    buffer_load_dwordx4 v[216:219], v21, s[68:71], s77 offen
    s_mov_b64 exec, -1
    s_mov_b32 exec_lo, 0xffffff
    s_mov_b32 exec_hi, 0
    s_mov_b32 s77, 32000
    buffer_load_dwordx4 v[220:223], v21, s[68:71], s77 offen
    s_mov_b64 exec, -1
    s_barrier
    s_waitcnt vmcnt(7)
    v_cmp_ne_u64 vcc, s[72:73], v[6:7]
    s_nop 1
    s_cbranch_vccnz L_nf_5
    v_mov_b32 v8, 163100
    v_mov_b32 v9, 1
    ds_write_b32 v8, v9
L_nf_5:
    v_cmp_ne_u64 vcc, s[72:73], v[4:5]
    s_nop 1
    s_cbranch_vccnz L_nf_6
    s_lshl_b32 s74, s78, 2
    s_add_u32 s74, s74, 163112
    v_mov_b32 v8, s74
    v_mov_b32 v9, 1
    ds_write_b32 v8, v9
L_nf_6:
    s_barrier
    s_waitcnt lgkmcnt(0)
    s_add_u32 s83, s78, 2
L_Yt:
    s_mul_i32 s84, s83, 17728
    s_add_u32 s84, s84, 81920
    s_add_u32 s93, s84, 8448
    s_mov_b32 s60, s24
    s_and_b32 s61, s25, 0xffff
    s_mov_b32 s62, 2621440
    s_mov_b32 s63, 0x20000
    v_mov_b32 v16, 163104
    ds_read_b32 v20, v16 offset:16
    v_mov_b32 v21, 163100
    ds_read_b32 v21, v21
    ds_read_b128 v[16:19], v16
    v_lshlrev_b32 v2, 3, v1
    s_waitcnt lgkmcnt(0)
    v_readfirstlane_b32 s14, v20
    v_readfirstlane_b32 s15, v21
    v_readfirstlane_b32 s72, v16
    v_readfirstlane_b32 s73, v17
    v_readfirstlane_b32 s99, v18
    s_mul_i32 s98, s14, 3277
    s_lshr_b32 s98, s98, 16
    s_lshl_b32 s98, s98, 9
    s_add_u32 s98, s98, 14745600
    s_lshl_b32 s85, s14, 2
    s_add_u32 s85, s85, s83
    s_lshl_b32 s74, s85, 12
    s_mul_i32 s100, s85, 4224
    s_add_u32 s100, s100, 8388608
    s_waitcnt vmcnt(20)
    s_barrier
    s_cmp_lt_u32 s14, 160
    s_cselect_b32 s99, s99, 0
    s_cmp_lg_u32 s99, 0
    s_cselect_b32 s101, s100, 0x7ff00000
    s_cmp_lg_u32 s99, 0
    s_cselect_b32 s75, 0x7ff00000, s98
    s_cmp_lt_u32 s14, 160
    s_cselect_b32 s75, s75, 0x7ff00000
    buffer_load_dwordx2 v[4:5], v2, s[44:47], s75 offen sc1
    buffer_load_dwordx4 v[48:51], v12, s[44:47], s101 offen offset:0 sc1
    buffer_load_dwordx4 v[52:55], v12, s[44:47], s101 offen offset:1024 sc1
    buffer_load_dwordx4 v[56:59], v12, s[44:47], s101 offen offset:2048 sc1
    buffer_load_dwordx4 v[60:63], v12, s[44:47], s101 offen offset:3072 sc1
    s_waitcnt vmcnt(11)
    s_cmp_lt_u32 s83, 2
    s_cbranch_scc1 L_nq_7
    s_waitcnt vmcnt(5)
    s_mov_b64 exec, s[86:87]
    ds_write_b128 v22, v[196:199] offset:0
    ds_write_b128 v22, v[200:203] offset:800
    ds_write_b128 v22, v[204:207] offset:1600
    ds_write_b128 v22, v[208:211] offset:2400
    ds_write_b128 v22, v[212:215] offset:3200
    ds_write_b128 v22, v[216:219] offset:4000
    s_and_b32 exec_lo, exec_lo, 0xffffff
    s_mov_b32 exec_hi, 0
    ds_write_b128 v22, v[220:223] offset:4800
    s_mov_b64 exec, -1
L_nq_7:
    s_barrier
    v_add_u32 v14, 68, v12
    v_lshrrev_b32 v41, 3, v14
    v_and_b32 v41, 32, v41
    v_xor_b32 v14, v14, v41
    v_add_u32 v14, s93, v14
    v_subrev_u32 v14, 64, v14
    v_add_u32 v15, 80, v12
    v_lshrrev_b32 v41, 3, v15
    v_and_b32 v41, 32, v41
    v_xor_b32 v15, v15, v41
    v_add_u32 v15, s93, v15
    v_subrev_u32 v15, 64, v15
    v_add_u32 v40, 72, v12
    v_lshrrev_b32 v41, 3, v40
    v_and_b32 v41, 32, v41
    v_xor_b32 v40, v40, v41
    v_add_u32 v40, s93, v40
    v_subrev_u32 v40, 64, v40
    v_add_u32 v13, s93, v12
    v_mov_b32 v32, 0
    v_mov_b32 v33, 0
    v_mov_b32 v34, 0
    v_mov_b32 v35, 0
    s_mov_b32 exec_lo, -1
    s_mov_b32 exec_hi, 0x3
    ds_write_b128 v13, v[32:35] offset:4096
    s_mov_b32 exec_lo, -1
    s_mov_b32 exec_hi, 0x1
    ds_write_b128 v13, v[32:35] offset:8704
    s_mov_b64 exec, 1
    ds_write_b128 v13, v[32:35]
    s_mov_b64 exec, -1
    s_waitcnt vmcnt(5)
    s_waitcnt lgkmcnt(0)
    s_barrier
    v_sub_u32 v78, 63, v1
    v_lshlrev_b32 v78, 2, v78
    s_mul_i32 s87, s10, 80
    s_mul_i32 s88, s83, 20
    s_add_u32 s87, s87, s88
    s_mul_i32 s88, s87, 4224
    s_lshl_b32 s75, s9, 7
    s_sub_u32 s88, s88, s75
    s_add_u32 s88, s88, 3968
    v_lshrrev_b32 v77, 3, v1
    v_mul_u32_u24 v77, 4224, v77
    v_and_b32 v79, 7, v1
    v_lshl_add_u32 v77, v79, 4, v77
    s_cmp_lt_u32 s14, 160
    s_cbranch_scc1 L_cvgo_8
    s_branch L_apart
L_cvgo_8:
    s_setprio 1
    s_cmp_lg_u32 s99, 0
    s_cbranch_scc1 L_hk_9
    s_waitcnt vmcnt(4)
    v_cmp_ne_u64 vcc, s[72:73], v[4:5]
    s_nop 1
    s_cbranch_vccz L_hk_10
    s_mov_b32 s94, 30000
L_poll_11:
    buffer_load_dwordx2 v[4:5], v2, s[44:47], s98 offen sc1
    s_waitcnt vmcnt(0)
    v_cmp_ne_u64 vcc, s[72:73], v[4:5]
    s_nop 1
    s_cbranch_vccz L_pdone_12
    s_sleep 4
    s_sub_u32 s94, s94, 1
    s_cbranch_scc0 L_poll_11
L_pdone_12:
L_hk_10:
    buffer_load_dwordx4 v[48:51], v12, s[44:47], s100 offen offset:0 sc1
    buffer_load_dwordx4 v[52:55], v12, s[44:47], s100 offen offset:1024 sc1
    buffer_load_dwordx4 v[56:59], v12, s[44:47], s100 offen offset:2048 sc1
    buffer_load_dwordx4 v[60:63], v12, s[44:47], s100 offen offset:3072 sc1
L_hk_9:
    v_add_u32 v13, s84, v12
    v_mov_b32 v234, 0
    s_nop 1
    v_mov_b32_dpp v234, v167 wave_shr:1 row_mask:0xf bank_mask:0xf
    ds_write_b128 v13, v[164:167] offset:4288
    v_alignbit_b32 v236, v164, v234, 16
    v_alignbit_b32 v237, v165, v164, 16
    v_alignbit_b32 v238, v166, v165, 16
    v_alignbit_b32 v239, v167, v166, 16
    ds_write_b128 v13, v[236:239] offset:64
    v_readlane_b32 s74, v167, 63
    s_nop 1
    v_mov_b32 v234, s74
    s_nop 1
    v_mov_b32_dpp v234, v171 wave_shr:1 row_mask:0xf bank_mask:0xf
    ds_write_b128 v13, v[168:171] offset:5312
    v_alignbit_b32 v236, v168, v234, 16
    v_alignbit_b32 v237, v169, v168, 16
    v_alignbit_b32 v238, v170, v169, 16
    v_alignbit_b32 v239, v171, v170, 16
    ds_write_b128 v13, v[236:239] offset:1088
    v_readlane_b32 s74, v171, 63
    s_nop 1
    v_mov_b32 v234, s74
    s_nop 1
    v_mov_b32_dpp v234, v175 wave_shr:1 row_mask:0xf bank_mask:0xf
    ds_write_b128 v13, v[172:175] offset:6336
    v_alignbit_b32 v236, v172, v234, 16
    v_alignbit_b32 v237, v173, v172, 16
    v_alignbit_b32 v238, v174, v173, 16
    v_alignbit_b32 v239, v175, v174, 16
    ds_write_b128 v13, v[236:239] offset:2112
    v_readlane_b32 s74, v175, 63
    s_nop 1
    v_mov_b32 v234, s74
    s_nop 1
    v_mov_b32_dpp v234, v179 wave_shr:1 row_mask:0xf bank_mask:0xf
    ds_write_b128 v13, v[176:179] offset:7360
    v_alignbit_b32 v236, v176, v234, 16
    v_alignbit_b32 v237, v177, v176, 16
    v_alignbit_b32 v238, v178, v177, 16
    v_alignbit_b32 v239, v179, v178, 16
    ds_write_b128 v13, v[236:239] offset:3136
    v_lshrrev_b32 v234, 2, v1
    v_and_b32 v235, 1, v234
    v_mul_u32_u24 v235, 4160, v235
    v_lshrrev_b32 v234, 1, v234
    v_mul_u32_u24 v234, 4224, v234
    v_add_u32 v235, v235, v234
    v_and_b32 v234, 3, v1
    v_lshl_add_u32 v235, v234, 4, v235
    v_add_u32 v235, s84, v235
    v_mov_b32 v236, 0
    v_mov_b32 v237, 0
    v_mov_b32 v238, 0
    v_mov_b32 v239, 0
    s_mov_b32 exec_lo, 0xffff
    s_mov_b32 exec_hi, 0
    ds_write_b128 v235, v[236:239]
    s_mov_b64 exec, -1
    s_waitcnt vmcnt(3)
    ds_write_b64 v40, v[48:49] offset:4616
    ds_write_b64 v15, v[50:51] offset:4616
    ds_write_b32 v14, v48 offset:0
    ds_write_b32 v14, v49 offset:4
    ds_write_b32 v14, v50 offset:8
    ds_write_b32 v15, v51 offset:0
    s_waitcnt vmcnt(2)
    ds_write_b64 v40, v[52:53] offset:5640
    ds_write_b64 v15, v[54:55] offset:5640
    ds_write_b32 v14, v52 offset:1024
    ds_write_b32 v14, v53 offset:1028
    ds_write_b32 v14, v54 offset:1032
    ds_write_b32 v15, v55 offset:1024
    s_waitcnt vmcnt(1)
    ds_write_b64 v40, v[56:57] offset:6664
    ds_write_b64 v15, v[58:59] offset:6664
    ds_write_b32 v14, v56 offset:2048
    ds_write_b32 v14, v57 offset:2052
    ds_write_b32 v14, v58 offset:2056
    ds_write_b32 v15, v59 offset:2048
    s_waitcnt vmcnt(0)
    ds_write_b64 v40, v[60:61] offset:7688
    ds_write_b64 v15, v[62:63] offset:7688
    ds_write_b32 v14, v60 offset:3072
    ds_write_b32 v14, v61 offset:3076
    ds_write_b32 v14, v62 offset:3080
    ds_write_b32 v15, v63 offset:3072
    s_cmp_lg_u32 s15, 1
    s_cbranch_scc1 L_np_13
    s_lshl_b32 s74, s9, 8
    s_add_u32 s74, s74, 14680064
    buffer_load_dword v76, v78, s[44:47], s74 offen sc1
    s_add_u32 s74, s88, 8388608
    buffer_load_dwordx4 v[64:67], v77, s[44:47], s74 offen sc1
    s_add_u32 s74, s88, 8422400
    buffer_load_dwordx4 v[68:71], v77, s[44:47], s74 offen sc1
    s_add_u32 s74, s88, 8456192
    s_mov_b32 exec_hi, 0
    buffer_load_dwordx4 v[72:75], v77, s[44:47], s74 offen sc1
    s_mov_b64 exec, -1
    s_mov_b32 s15, 2
L_np_13:
    v_add_u32 v13, s93, v12
    v_and_b32 v2, 15, v1
    v_lshrrev_b32 v3, 4, v1
    v_and_b32 v4, 1, v2
    v_lshrrev_b32 v5, 1, v2
    v_mul_u32_u24 v6, 4224, v4
    v_lshl_add_u32 v6, v3, 4, v6
    v_lshl_add_u32 v6, v5, 3, v6
    v_add_u32 v6, s84, v6
    v_lshlrev_b32 v7, 4, v3
    v_lshlrev_b32 v8, 6, v5
    v_sub_u32 v7, v7, v8
    v_add_u32 v7, 512, v7
    v_mul_u32_u24 v9, 4616, v4
    v_add_u32 v9, s93, v9
    v_subrev_u32 v9, 64, v9
    v_lshrrev_b32 v10, 3, v7
    v_and_b32 v10, 32, v10
    v_xor_b32 v10, v10, v7
    v_add_u32 v10, v10, v9
    v_add_u32 v7, 64, v7
    s_waitcnt lgkmcnt(0)
    ds_read_b64 v[96:97], v6 offset:0
    ds_read_b64 v[98:99], v6 offset:8
    ds_read_b64 v[128:129], v10 offset:3584
    ds_read_b64 v[130:131], v10 offset:3592
    ds_read_b64 v[100:101], v6 offset:512
    ds_read_b64 v[102:103], v6 offset:520
    ds_read_b64 v[132:133], v10 offset:3072
    ds_read_b64 v[134:135], v10 offset:3080
    ds_read_b64 v[104:105], v6 offset:1024
    ds_read_b64 v[106:107], v6 offset:1032
    ds_read_b64 v[136:137], v10 offset:2560
    ds_read_b64 v[138:139], v10 offset:2568
    ds_read_b64 v[108:109], v6 offset:1536
    ds_read_b64 v[110:111], v6 offset:1544
    ds_read_b64 v[140:141], v10 offset:2048
    ds_read_b64 v[142:143], v10 offset:2056
    ds_read_b64 v[112:113], v6 offset:2048
    ds_read_b64 v[114:115], v6 offset:2056
    ds_read_b64 v[144:145], v10 offset:1536
    ds_read_b64 v[146:147], v10 offset:1544
    ds_read_b64 v[116:117], v6 offset:2560
    ds_read_b64 v[118:119], v6 offset:2568
    ds_read_b64 v[148:149], v10 offset:1024
    ds_read_b64 v[150:151], v10 offset:1032
    ds_read_b64 v[120:121], v6 offset:3072
    ds_read_b64 v[122:123], v6 offset:3080
    ds_read_b64 v[152:153], v10 offset:512
    ds_read_b64 v[154:155], v10 offset:520
    ds_read_b64 v[124:125], v6 offset:3584
    ds_read_b64 v[126:127], v6 offset:3592
    ds_read_b64 v[156:157], v10 offset:0
    ds_read_b64 v[158:159], v10 offset:8
    v_mov_b32 v224, 0
    v_mov_b32 v225, 0
    v_mov_b32 v226, 0
    v_mov_b32 v227, 0
    v_mov_b32 v228, 0
    v_mov_b32 v229, 0
    v_mov_b32 v230, 0
    v_mov_b32 v231, 0
    v_mov_b32 v232, 0
    v_mov_b32 v233, 0
    v_mov_b32 v234, 0
    v_mov_b32 v235, 0
    v_mov_b32 v236, 0
    v_mov_b32 v237, 0
    v_mov_b32 v238, 0
    v_mov_b32 v239, 0
    v_mov_b32 v240, 0
    v_mov_b32 v241, 0
    v_mov_b32 v242, 0
    v_mov_b32 v243, 0
    v_mov_b32 v244, 0
    v_mov_b32 v245, 0
    v_mov_b32 v246, 0
    v_mov_b32 v247, 0
    v_mov_b32 v248, 0
    v_mov_b32 v249, 0
    v_mov_b32 v250, 0
    v_mov_b32 v251, 0
    v_mov_b32 v252, 0
    v_mov_b32 v253, 0
    v_mov_b32 v254, 0
    v_mov_b32 v255, 0
    s_mov_b32 s86, 0
L_cv:
    v_lshrrev_b32 v10, 3, v7
    v_and_b32 v10, 32, v10
    v_xor_b32 v10, v10, v7
    v_add_u32 v10, v10, v9
    v_add_u32 v7, 64, v7
    s_waitcnt lgkmcnt(12)
    v_mfma_f32_16x16x32_bf16 v[224:227], v[96:99], v[128:131], v[224:227]
    ds_read_b64 v[160:161], v6 offset:64
    v_mfma_f32_16x16x32_bf16 v[228:231], v[96:99], v[132:135], v[228:231]
    ds_read_b64 v[162:163], v6 offset:72
    v_mfma_f32_16x16x32_bf16 v[228:231], v[100:103], v[128:131], v[228:231]
    ds_read_b64 v[192:193], v10 offset:3584
    v_mfma_f32_16x16x32_bf16 v[232:235], v[96:99], v[136:139], v[232:235]
    ds_read_b64 v[194:195], v10 offset:3592
    v_mfma_f32_16x16x32_bf16 v[232:235], v[100:103], v[132:135], v[232:235]
    ds_read_b64 v[164:165], v6 offset:576
    v_mfma_f32_16x16x32_bf16 v[232:235], v[104:107], v[128:131], v[232:235]
    ds_read_b64 v[166:167], v6 offset:584
    v_mfma_f32_16x16x32_bf16 v[236:239], v[96:99], v[140:143], v[236:239]
    ds_read_b64 v[196:197], v10 offset:3072
    v_mfma_f32_16x16x32_bf16 v[236:239], v[100:103], v[136:139], v[236:239]
    ds_read_b64 v[198:199], v10 offset:3080
    v_mfma_f32_16x16x32_bf16 v[236:239], v[104:107], v[132:135], v[236:239]
    ds_read_b64 v[168:169], v6 offset:1088
    v_mfma_f32_16x16x32_bf16 v[236:239], v[108:111], v[128:131], v[236:239]
    ds_read_b64 v[170:171], v6 offset:1096
    v_mfma_f32_16x16x32_bf16 v[240:243], v[96:99], v[144:147], v[240:243]
    ds_read_b64 v[200:201], v10 offset:2560
    v_mfma_f32_16x16x32_bf16 v[240:243], v[100:103], v[140:143], v[240:243]
    ds_read_b64 v[202:203], v10 offset:2568
    v_mfma_f32_16x16x32_bf16 v[240:243], v[104:107], v[136:139], v[240:243]
    ds_read_b64 v[172:173], v6 offset:1600
    v_mfma_f32_16x16x32_bf16 v[240:243], v[108:111], v[132:135], v[240:243]
    ds_read_b64 v[174:175], v6 offset:1608
    v_mfma_f32_16x16x32_bf16 v[240:243], v[112:115], v[128:131], v[240:243]
    ds_read_b64 v[204:205], v10 offset:2048
    s_waitcnt lgkmcnt(15)
    v_mfma_f32_16x16x32_bf16 v[244:247], v[96:99], v[148:151], v[244:247]
    ds_read_b64 v[206:207], v10 offset:2056
    v_mfma_f32_16x16x32_bf16 v[244:247], v[100:103], v[144:147], v[244:247]
    ds_read_b64 v[176:177], v6 offset:2112
    v_mfma_f32_16x16x32_bf16 v[244:247], v[104:107], v[140:143], v[244:247]
    ds_read_b64 v[178:179], v6 offset:2120
    v_mfma_f32_16x16x32_bf16 v[244:247], v[108:111], v[136:139], v[244:247]
    ds_read_b64 v[208:209], v10 offset:1536
    v_mfma_f32_16x16x32_bf16 v[244:247], v[112:115], v[132:135], v[244:247]
    ds_read_b64 v[210:211], v10 offset:1544
    v_mfma_f32_16x16x32_bf16 v[244:247], v[116:119], v[128:131], v[244:247]
    ds_read_b64 v[180:181], v6 offset:2624
    v_mfma_f32_16x16x32_bf16 v[248:251], v[96:99], v[152:155], v[248:251]
    ds_read_b64 v[182:183], v6 offset:2632
    v_mfma_f32_16x16x32_bf16 v[248:251], v[100:103], v[148:151], v[248:251]
    ds_read_b64 v[212:213], v10 offset:1024
    v_mfma_f32_16x16x32_bf16 v[248:251], v[104:107], v[144:147], v[248:251]
    ds_read_b64 v[214:215], v10 offset:1032
    v_mfma_f32_16x16x32_bf16 v[248:251], v[108:111], v[140:143], v[248:251]
    ds_read_b64 v[184:185], v6 offset:3136
    v_mfma_f32_16x16x32_bf16 v[248:251], v[112:115], v[136:139], v[248:251]
    ds_read_b64 v[186:187], v6 offset:3144
    v_mfma_f32_16x16x32_bf16 v[248:251], v[116:119], v[132:135], v[248:251]
    ds_read_b64 v[216:217], v10 offset:512
    v_mfma_f32_16x16x32_bf16 v[248:251], v[120:123], v[128:131], v[248:251]
    ds_read_b64 v[218:219], v10 offset:520
    v_mfma_f32_16x16x32_bf16 v[252:255], v[96:99], v[156:159], v[252:255]
    ds_read_b64 v[188:189], v6 offset:3648
    v_mfma_f32_16x16x32_bf16 v[252:255], v[100:103], v[152:155], v[252:255]
    ds_read_b64 v[190:191], v6 offset:3656
    v_mfma_f32_16x16x32_bf16 v[252:255], v[104:107], v[148:151], v[252:255]
    ds_read_b64 v[220:221], v10 offset:0
    v_mfma_f32_16x16x32_bf16 v[252:255], v[108:111], v[144:147], v[252:255]
    ds_read_b64 v[222:223], v10 offset:8
    v_mfma_f32_16x16x32_bf16 v[252:255], v[112:115], v[140:143], v[252:255]
    v_mfma_f32_16x16x32_bf16 v[252:255], v[116:119], v[136:139], v[252:255]
    v_mfma_f32_16x16x32_bf16 v[252:255], v[120:123], v[132:135], v[252:255]
    v_mfma_f32_16x16x32_bf16 v[252:255], v[124:127], v[128:131], v[252:255]
    v_add_u32 v6, 128, v6
    v_lshrrev_b32 v10, 3, v7
    v_and_b32 v10, 32, v10
    v_xor_b32 v10, v10, v7
    v_add_u32 v10, v10, v9
    v_add_u32 v7, 64, v7
    s_waitcnt lgkmcnt(12)
    v_mfma_f32_16x16x32_bf16 v[224:227], v[160:163], v[192:195], v[224:227]
    ds_read_b64 v[96:97], v6 offset:0
    v_mfma_f32_16x16x32_bf16 v[228:231], v[160:163], v[196:199], v[228:231]
    ds_read_b64 v[98:99], v6 offset:8
    v_mfma_f32_16x16x32_bf16 v[228:231], v[164:167], v[192:195], v[228:231]
    ds_read_b64 v[128:129], v10 offset:3584
    v_mfma_f32_16x16x32_bf16 v[232:235], v[160:163], v[200:203], v[232:235]
    ds_read_b64 v[130:131], v10 offset:3592
    v_mfma_f32_16x16x32_bf16 v[232:235], v[164:167], v[196:199], v[232:235]
    ds_read_b64 v[100:101], v6 offset:512
    v_mfma_f32_16x16x32_bf16 v[232:235], v[168:171], v[192:195], v[232:235]
    ds_read_b64 v[102:103], v6 offset:520
    v_mfma_f32_16x16x32_bf16 v[236:239], v[160:163], v[204:207], v[236:239]
    ds_read_b64 v[132:133], v10 offset:3072
    v_mfma_f32_16x16x32_bf16 v[236:239], v[164:167], v[200:203], v[236:239]
    ds_read_b64 v[134:135], v10 offset:3080
    v_mfma_f32_16x16x32_bf16 v[236:239], v[168:171], v[196:199], v[236:239]
    ds_read_b64 v[104:105], v6 offset:1024
    v_mfma_f32_16x16x32_bf16 v[236:239], v[172:175], v[192:195], v[236:239]
    ds_read_b64 v[106:107], v6 offset:1032
    v_mfma_f32_16x16x32_bf16 v[240:243], v[160:163], v[208:211], v[240:243]
    ds_read_b64 v[136:137], v10 offset:2560
    v_mfma_f32_16x16x32_bf16 v[240:243], v[164:167], v[204:207], v[240:243]
    ds_read_b64 v[138:139], v10 offset:2568
    v_mfma_f32_16x16x32_bf16 v[240:243], v[168:171], v[200:203], v[240:243]
    ds_read_b64 v[108:109], v6 offset:1536
    v_mfma_f32_16x16x32_bf16 v[240:243], v[172:175], v[196:199], v[240:243]
    ds_read_b64 v[110:111], v6 offset:1544
    v_mfma_f32_16x16x32_bf16 v[240:243], v[176:179], v[192:195], v[240:243]
    ds_read_b64 v[140:141], v10 offset:2048
    s_waitcnt lgkmcnt(15)
    v_mfma_f32_16x16x32_bf16 v[244:247], v[160:163], v[212:215], v[244:247]
    ds_read_b64 v[142:143], v10 offset:2056
    v_mfma_f32_16x16x32_bf16 v[244:247], v[164:167], v[208:211], v[244:247]
    ds_read_b64 v[112:113], v6 offset:2048
    v_mfma_f32_16x16x32_bf16 v[244:247], v[168:171], v[204:207], v[244:247]
    ds_read_b64 v[114:115], v6 offset:2056
    v_mfma_f32_16x16x32_bf16 v[244:247], v[172:175], v[200:203], v[244:247]
    ds_read_b64 v[144:145], v10 offset:1536
    v_mfma_f32_16x16x32_bf16 v[244:247], v[176:179], v[196:199], v[244:247]
    ds_read_b64 v[146:147], v10 offset:1544
    v_mfma_f32_16x16x32_bf16 v[244:247], v[180:183], v[192:195], v[244:247]
    ds_read_b64 v[116:117], v6 offset:2560
    v_mfma_f32_16x16x32_bf16 v[248:251], v[160:163], v[216:219], v[248:251]
    ds_read_b64 v[118:119], v6 offset:2568
    v_mfma_f32_16x16x32_bf16 v[248:251], v[164:167], v[212:215], v[248:251]
    ds_read_b64 v[148:149], v10 offset:1024
    v_mfma_f32_16x16x32_bf16 v[248:251], v[168:171], v[208:211], v[248:251]
    ds_read_b64 v[150:151], v10 offset:1032
    v_mfma_f32_16x16x32_bf16 v[248:251], v[172:175], v[204:207], v[248:251]
    ds_read_b64 v[120:121], v6 offset:3072
    v_mfma_f32_16x16x32_bf16 v[248:251], v[176:179], v[200:203], v[248:251]
    ds_read_b64 v[122:123], v6 offset:3080
    v_mfma_f32_16x16x32_bf16 v[248:251], v[180:183], v[196:199], v[248:251]
    ds_read_b64 v[152:153], v10 offset:512
    v_mfma_f32_16x16x32_bf16 v[248:251], v[184:187], v[192:195], v[248:251]
    ds_read_b64 v[154:155], v10 offset:520
    v_mfma_f32_16x16x32_bf16 v[252:255], v[160:163], v[220:223], v[252:255]
    ds_read_b64 v[124:125], v6 offset:3584
    v_mfma_f32_16x16x32_bf16 v[252:255], v[164:167], v[216:219], v[252:255]
    ds_read_b64 v[126:127], v6 offset:3592
    v_mfma_f32_16x16x32_bf16 v[252:255], v[168:171], v[212:215], v[252:255]
    ds_read_b64 v[156:157], v10 offset:0
    v_mfma_f32_16x16x32_bf16 v[252:255], v[172:175], v[208:211], v[252:255]
    ds_read_b64 v[158:159], v10 offset:8
    v_mfma_f32_16x16x32_bf16 v[252:255], v[176:179], v[204:207], v[252:255]
    v_mfma_f32_16x16x32_bf16 v[252:255], v[180:183], v[200:203], v[252:255]
    v_mfma_f32_16x16x32_bf16 v[252:255], v[184:187], v[196:199], v[252:255]
    v_mfma_f32_16x16x32_bf16 v[252:255], v[188:191], v[192:195], v[252:255]
    s_add_u32 s86, s86, 1
    s_cmp_lt_u32 s86, 4
    s_cbranch_scc1 L_cv
    s_waitcnt lgkmcnt(0)
    v_mfma_f32_16x16x32_bf16 v[224:227], v[96:99], v[128:131], v[224:227]
    v_mfma_f32_16x16x32_bf16 v[228:231], v[100:103], v[128:131], v[228:231]
    v_mfma_f32_16x16x32_bf16 v[232:235], v[104:107], v[128:131], v[232:235]
    v_mfma_f32_16x16x32_bf16 v[236:239], v[108:111], v[128:131], v[236:239]
    v_mfma_f32_16x16x32_bf16 v[240:243], v[112:115], v[128:131], v[240:243]
    v_mfma_f32_16x16x32_bf16 v[244:247], v[116:119], v[128:131], v[244:247]
    v_mfma_f32_16x16x32_bf16 v[248:251], v[120:123], v[128:131], v[248:251]
    v_mfma_f32_16x16x32_bf16 v[252:255], v[124:127], v[128:131], v[252:255]
    v_lshlrev_b32 v8, 4, v3
    v_lshl_add_u32 v8, v4, 2, v8
    v_lshl_add_u32 v8, v5, 6, v8
    v_sub_u32 v8, 3572, v8
    v_add_u32 v8, s93, v8
    s_nop 4
    v_cvt_pk_bf16_f32 v16, v227, v226
    v_cvt_pk_bf16_f32 v17, v225, v224
    v_cvt_pk_bf16_f32 v18, v231, v230
    v_cvt_pk_bf16_f32 v19, v229, v228
    v_cvt_pk_bf16_f32 v20, v235, v234
    v_cvt_pk_bf16_f32 v21, v233, v232
    v_cvt_pk_bf16_f32 v22, v239, v238
    v_cvt_pk_bf16_f32 v23, v237, v236
    v_cvt_pk_bf16_f32 v24, v243, v242
    v_cvt_pk_bf16_f32 v25, v241, v240
    v_cvt_pk_bf16_f32 v26, v247, v246
    v_cvt_pk_bf16_f32 v27, v245, v244
    v_cvt_pk_bf16_f32 v28, v251, v250
    v_cvt_pk_bf16_f32 v29, v249, v248
    v_cvt_pk_bf16_f32 v30, v255, v254
    v_cvt_pk_bf16_f32 v31, v253, v252
    ds_write2_b32 v8, v16, v17 offset0:128 offset1:130
    ds_write2_b32 v8, v18, v19 offset0:0 offset1:2
    v_subrev_u32 v8, 1024, v8
    ds_write2_b32 v8, v20, v21 offset0:128 offset1:130
    ds_write2_b32 v8, v22, v23 offset0:0 offset1:2
    v_subrev_u32 v8, 1024, v8
    ds_write2_b32 v8, v24, v25 offset0:128 offset1:130
    ds_write2_b32 v8, v26, v27 offset0:0 offset1:2
    v_subrev_u32 v8, 1024, v8
    ds_write2_b32 v8, v28, v29 offset0:128 offset1:130
    ds_write2_b32 v8, v30, v31 offset0:0 offset1:2
    s_waitcnt lgkmcnt(0)
    ds_read_b128 v[32:35], v13 offset:0
    ds_read_b128 v[36:39], v13 offset:1024
    ds_read_b128 v[40:43], v13 offset:2048
    ds_read_b128 v[44:47], v13 offset:3072
    s_mul_i32 s74, s85, 4224
    s_add_u32 s74, s74, 11534336
    s_waitcnt lgkmcnt(3)
    buffer_store_dwordx4 v[32:35], v12, s[44:47], s74 offen offset:0 sc1
    s_waitcnt lgkmcnt(2)
    buffer_store_dwordx4 v[36:39], v12, s[44:47], s74 offen offset:1024 sc1
    s_waitcnt lgkmcnt(1)
    buffer_store_dwordx4 v[40:43], v12, s[44:47], s74 offen offset:2048 sc1
    s_waitcnt lgkmcnt(0)
    buffer_store_dwordx4 v[44:47], v12, s[44:47], s74 offen offset:3072 sc1
    s_waitcnt vmcnt(0)
    s_lshl_b32 s74, s85, 3
    s_add_u32 s74, s74, 14770176
    v_mov_b32 v48, s72
    v_mov_b32 v49, s73
    v_mov_b32 v50, 0
    s_mov_b64 exec, 1
    buffer_store_dwordx2 v[48:49], v50, s[44:47], s74 offen sc1
    s_mov_b64 exec, -1
    s_setprio 0
L_apart:
    s_setprio 0
    s_mov_b32 s94, 240000
    v_mov_b32 v152, 163132
L_lw_14:
    ds_read_b32 v148, v152
    s_waitcnt lgkmcnt(0)
    s_nop 0
    v_readfirstlane_b32 s95, v148
    s_nop 1
    s_cmp_ge_u32 s95, 1
    s_cbranch_scc1 L_lwd_15
    s_sleep 2
    s_sub_u32 s94, s94, 1
    s_cbranch_scc0 L_lw_14
L_lwd_15:
    s_cmp_eq_u32 s15, 2
    s_cbranch_scc1 L_pre_16
    s_cmp_eq_u32 s15, 1
    s_cbranch_scc1 L_np_17
    v_min_u32 v2, 15, v1
    v_lshlrev_b32 v2, 3, v2
    s_lshl_b32 s74, s9, 7
    s_add_u32 s74, s74, 14753792
    s_mov_b32 s94, 30000
L_poll_18:
    buffer_load_dwordx2 v[4:5], v2, s[44:47], s74 offen sc1
    s_waitcnt vmcnt(0)
    v_cmp_ne_u64 vcc, s[72:73], v[4:5]
    s_nop 1
    s_cbranch_vccz L_pdone_19
    s_sleep 4
    s_sub_u32 s94, s94, 1
    s_cbranch_scc0 L_poll_18
L_pdone_19:
L_np_17:
    s_lshl_b32 s74, s9, 8
    s_add_u32 s74, s74, 14680064
    buffer_load_dword v76, v78, s[44:47], s74 offen sc1
    s_add_u32 s74, s88, 8388608
    buffer_load_dwordx4 v[64:67], v77, s[44:47], s74 offen sc1
    s_add_u32 s74, s88, 8422400
    buffer_load_dwordx4 v[68:71], v77, s[44:47], s74 offen sc1
    s_add_u32 s74, s88, 8456192
    s_mov_b32 exec_hi, 0
    buffer_load_dwordx4 v[72:75], v77, s[44:47], s74 offen sc1
    s_mov_b64 exec, -1
    s_waitcnt vmcnt(0)
L_pre_16:
    v_sub_u32 v3, 63, v1
    s_lshl_b32 s74, s87, 1
    s_add_u32 s26, s26, s74
    s_addc_u32 s27, s27, 0
    s_load_dwordx8 s[48:55], s[26:27], 0
    s_load_dwordx2 s[56:57], s[26:27], 32
    v_add_u32 v13, s84, v12
    v_mul_u32_u24 v7, 160, v3
    s_mul_i32 s74, s83, 40
    s_add_u32 s74, s74, 152832
    v_add_u32 v7, s74, v7
    ds_read_b64 v[80:81], v7 offset:0
    ds_read_b64 v[82:83], v7 offset:8
    ds_read_b64 v[84:85], v7 offset:16
    ds_read_b64 v[86:87], v7 offset:24
    ds_read_b64 v[88:89], v7 offset:32
    ds_write_b128 v13, v[64:67] offset:0
    ds_write_b128 v13, v[68:71] offset:1024
    s_mov_b32 exec_hi, 0
    ds_write_b128 v13, v[72:75] offset:2048
    s_mov_b64 exec, -1
    v_and_b32 v8, 15, v1
    v_lshrrev_b32 v9, 2, v8
    v_lshlrev_b32 v9, 7, v9
    v_and_b32 v8, 3, v8
    v_lshl_add_u32 v9, v8, 3, v9
    v_lshrrev_b32 v8, 4, v1
    v_lshl_add_u32 v9, v8, 5, v9
    v_add_u32 v9, s84, v9
    v_add_u32 v2, 163328, v78
    ds_write_b32 v2, v76
    s_waitcnt lgkmcnt(0)
    ds_read_b64_tr_b16 v[150:151], v9 offset:0
    ds_read_b64_tr_b16 v[152:153], v9 offset:512
    ds_read_b64_tr_b16 v[154:155], v9 offset:1024
    ds_read_b64_tr_b16 v[156:157], v9 offset:1536
    ds_read_b64_tr_b16 v[158:159], v9 offset:2048
    v_lshlrev_b32 v96, 16, v80
    v_and_b32 v97, 0xffff0000, v80
    v_mul_f32 v96, v96, v76
    v_mul_f32 v97, v97, v76
    v_lshlrev_b32 v98, 16, v81
    v_and_b32 v99, 0xffff0000, v81
    v_mul_f32 v98, v98, v76
    v_mul_f32 v99, v99, v76
    v_lshlrev_b32 v100, 16, v82
    v_and_b32 v101, 0xffff0000, v82
    v_mul_f32 v100, v100, v76
    v_mul_f32 v101, v101, v76
    v_lshlrev_b32 v102, 16, v83
    v_and_b32 v103, 0xffff0000, v83
    v_mul_f32 v102, v102, v76
    v_mul_f32 v103, v103, v76
    v_lshlrev_b32 v104, 16, v84
    v_and_b32 v105, 0xffff0000, v84
    v_mul_f32 v104, v104, v76
    v_mul_f32 v105, v105, v76
    v_lshlrev_b32 v106, 16, v85
    v_and_b32 v107, 0xffff0000, v85
    v_mul_f32 v106, v106, v76
    v_mul_f32 v107, v107, v76
    v_lshlrev_b32 v108, 16, v86
    v_and_b32 v109, 0xffff0000, v86
    v_mul_f32 v108, v108, v76
    v_mul_f32 v109, v109, v76
    v_lshlrev_b32 v110, 16, v87
    v_and_b32 v111, 0xffff0000, v87
    v_mul_f32 v110, v110, v76
    v_mul_f32 v111, v111, v76
    v_lshlrev_b32 v112, 16, v88
    v_and_b32 v113, 0xffff0000, v88
    v_mul_f32 v112, v112, v76
    v_mul_f32 v113, v113, v76
    v_lshlrev_b32 v114, 16, v89
    v_and_b32 v115, 0xffff0000, v89
    v_mul_f32 v114, v114, v76
    v_mul_f32 v115, v115, v76
    s_waitcnt lgkmcnt(0)
    s_lshl_b32 s58, s48, 16
    s_and_b32 s59, s48, 0xffff0000
    v_lshlrev_b32 v120, 16, v150
    v_and_b32 v121, 0xffff0000, v150
    v_mul_f32 v120, s58, v120
    v_mul_f32 v121, s59, v121
    s_lshl_b32 s58, s49, 16
    s_and_b32 s59, s49, 0xffff0000
    v_lshlrev_b32 v122, 16, v151
    v_and_b32 v123, 0xffff0000, v151
    v_mul_f32 v122, s58, v122
    v_mul_f32 v123, s59, v123
    s_lshl_b32 s58, s50, 16
    s_and_b32 s59, s50, 0xffff0000
    v_lshlrev_b32 v124, 16, v152
    v_and_b32 v125, 0xffff0000, v152
    v_mul_f32 v124, s58, v124
    v_mul_f32 v125, s59, v125
    s_lshl_b32 s58, s51, 16
    s_and_b32 s59, s51, 0xffff0000
    v_lshlrev_b32 v126, 16, v153
    v_and_b32 v127, 0xffff0000, v153
    v_mul_f32 v126, s58, v126
    v_mul_f32 v127, s59, v127
    s_lshl_b32 s58, s52, 16
    s_and_b32 s59, s52, 0xffff0000
    v_lshlrev_b32 v128, 16, v154
    v_and_b32 v129, 0xffff0000, v154
    v_mul_f32 v128, s58, v128
    v_mul_f32 v129, s59, v129
    s_lshl_b32 s58, s53, 16
    s_and_b32 s59, s53, 0xffff0000
    v_lshlrev_b32 v130, 16, v155
    v_and_b32 v131, 0xffff0000, v155
    v_mul_f32 v130, s58, v130
    v_mul_f32 v131, s59, v131
    s_lshl_b32 s58, s54, 16
    s_and_b32 s59, s54, 0xffff0000
    v_lshlrev_b32 v132, 16, v156
    v_and_b32 v133, 0xffff0000, v156
    v_mul_f32 v132, s58, v132
    v_mul_f32 v133, s59, v133
    s_lshl_b32 s58, s55, 16
    s_and_b32 s59, s55, 0xffff0000
    v_lshlrev_b32 v134, 16, v157
    v_and_b32 v135, 0xffff0000, v157
    v_mul_f32 v134, s58, v134
    v_mul_f32 v135, s59, v135
    s_lshl_b32 s58, s56, 16
    s_and_b32 s59, s56, 0xffff0000
    v_lshlrev_b32 v136, 16, v158
    v_and_b32 v137, 0xffff0000, v158
    v_mul_f32 v136, s58, v136
    v_mul_f32 v137, s59, v137
    s_lshl_b32 s58, s57, 16
    s_and_b32 s59, s57, 0xffff0000
    v_lshlrev_b32 v138, 16, v159
    v_and_b32 v139, 0xffff0000, v159
    v_mul_f32 v138, s58, v138
    v_mul_f32 v139, s59, v139
    s_mov_b32 s94, 240000
    v_mov_b32 v164, 163128
L_lw_20:
    ds_read_b32 v160, v164
    s_waitcnt lgkmcnt(0)
    s_nop 0
    v_readfirstlane_b32 s95, v160
    s_nop 1
    s_cmp_ge_u32 s95, 1
    s_cbranch_scc1 L_lwd_21
    s_sleep 2
    s_sub_u32 s94, s94, 1
    s_cbranch_scc0 L_lw_20
L_lwd_21:
    v_min_u32 v2, 19, v1
    v_lshlrev_b32 v2, 3, v2
    s_lshl_b32 s74, s87, 3
    s_add_u32 s74, s74, 14770176
    s_mov_b32 s94, 30000
L_poll_22:
    buffer_load_dwordx2 v[146:147], v2, s[44:47], s74 offen sc1
    s_waitcnt vmcnt(0)
    v_cmp_ne_u64 vcc, s[72:73], v[146:147]
    s_nop 1
    s_cbranch_vccz L_pdone_23
    s_sleep 12
    s_sub_u32 s94, s94, 1
    s_cbranch_scc0 L_poll_22
L_pdone_23:
    s_setprio 2
    s_add_u32 s74, s88, 11534336
    buffer_load_dwordx4 v[16:19], v77, s[44:47], s74 offen sc1
    s_add_u32 s74, s88, 11568128
    buffer_load_dwordx4 v[20:23], v77, s[44:47], s74 offen sc1
    s_add_u32 s74, s88, 11601920
    s_mov_b32 exec_hi, 0
    buffer_load_dwordx4 v[24:27], v77, s[44:47], s74 offen sc1
    s_mov_b64 exec, -1
    s_waitcnt vmcnt(2)
    ds_write_b128 v13, v[16:19] offset:0
    s_waitcnt vmcnt(1)
    ds_write_b128 v13, v[20:23] offset:1024
    s_waitcnt vmcnt(0)
    s_mov_b32 exec_hi, 0
    ds_write_b128 v13, v[24:27] offset:2048
    s_mov_b64 exec, -1
    s_waitcnt lgkmcnt(0)
    ds_read_b64_tr_b16 v[150:151], v9 offset:0
    ds_read_b64_tr_b16 v[152:153], v9 offset:512
    ds_read_b64_tr_b16 v[154:155], v9 offset:1024
    ds_read_b64_tr_b16 v[156:157], v9 offset:1536
    ds_read_b64_tr_b16 v[158:159], v9 offset:2048
    s_waitcnt lgkmcnt(4)
    v_lshlrev_b32 v144, 16, v150
    v_and_b32 v145, 0xffff0000, v150
    v_add_f32 v144, v144, v120
    v_add_f32 v145, v145, v121
    v_mul_f32 v144, v144, v96
    v_mul_f32 v145, v145, v97
    v_cvt_pk_bf16_f32 v80, v144, v145
    v_lshlrev_b32 v144, 16, v151
    v_and_b32 v145, 0xffff0000, v151
    v_add_f32 v144, v144, v122
    v_add_f32 v145, v145, v123
    v_mul_f32 v144, v144, v98
    v_mul_f32 v145, v145, v99
    v_cvt_pk_bf16_f32 v81, v144, v145
    ds_write_b64 v7, v[80:81] offset:0
    s_waitcnt lgkmcnt(4)
    v_lshlrev_b32 v144, 16, v152
    v_and_b32 v145, 0xffff0000, v152
    v_add_f32 v144, v144, v124
    v_add_f32 v145, v145, v125
    v_mul_f32 v144, v144, v100
    v_mul_f32 v145, v145, v101
    v_cvt_pk_bf16_f32 v82, v144, v145
    v_lshlrev_b32 v144, 16, v153
    v_and_b32 v145, 0xffff0000, v153
    v_add_f32 v144, v144, v126
    v_add_f32 v145, v145, v127
    v_mul_f32 v144, v144, v102
    v_mul_f32 v145, v145, v103
    v_cvt_pk_bf16_f32 v83, v144, v145
    ds_write_b64 v7, v[82:83] offset:8
    s_waitcnt lgkmcnt(4)
    v_lshlrev_b32 v144, 16, v154
    v_and_b32 v145, 0xffff0000, v154
    v_add_f32 v144, v144, v128
    v_add_f32 v145, v145, v129
    v_mul_f32 v144, v144, v104
    v_mul_f32 v145, v145, v105
    v_cvt_pk_bf16_f32 v84, v144, v145
    v_lshlrev_b32 v144, 16, v155
    v_and_b32 v145, 0xffff0000, v155
    v_add_f32 v144, v144, v130
    v_add_f32 v145, v145, v131
    v_mul_f32 v144, v144, v106
    v_mul_f32 v145, v145, v107
    v_cvt_pk_bf16_f32 v85, v144, v145
    ds_write_b64 v7, v[84:85] offset:16
    s_waitcnt lgkmcnt(4)
    v_lshlrev_b32 v144, 16, v156
    v_and_b32 v145, 0xffff0000, v156
    v_add_f32 v144, v144, v132
    v_add_f32 v145, v145, v133
    v_mul_f32 v144, v144, v108
    v_mul_f32 v145, v145, v109
    v_cvt_pk_bf16_f32 v86, v144, v145
    v_lshlrev_b32 v144, 16, v157
    v_and_b32 v145, 0xffff0000, v157
    v_add_f32 v144, v144, v134
    v_add_f32 v145, v145, v135
    v_mul_f32 v144, v144, v110
    v_mul_f32 v145, v145, v111
    v_cvt_pk_bf16_f32 v87, v144, v145
    ds_write_b64 v7, v[86:87] offset:24
    s_waitcnt lgkmcnt(4)
    v_lshlrev_b32 v144, 16, v158
    v_and_b32 v145, 0xffff0000, v158
    v_add_f32 v144, v144, v136
    v_add_f32 v145, v145, v137
    v_mul_f32 v144, v144, v112
    v_mul_f32 v145, v145, v113
    v_cvt_pk_bf16_f32 v88, v144, v145
    v_lshlrev_b32 v144, 16, v159
    v_and_b32 v145, 0xffff0000, v159
    v_add_f32 v144, v144, v138
    v_add_f32 v145, v145, v139
    v_mul_f32 v144, v144, v114
    v_mul_f32 v145, v145, v115
    v_cvt_pk_bf16_f32 v89, v144, v145
    ds_write_b64 v7, v[88:89] offset:32
    s_branch L_final
L_X:
    s_setprio 2
    v_mov_b32 v16, 0
    v_mov_b32 v17, 0
    v_mov_b32 v18, 0
    v_mov_b32 v19, 0
    v_add_u32 v20, 163072, v12
    s_mov_b64 exec, 15
    ds_write_b128 v20, v[16:19]
    s_mov_b64 exec, -1
    s_lshr_b32 s74, s3, 1
    s_and_b32 s75, s3, 1
    v_lshrrev_b32 v14, 5, v1
    v_bfe_u32 v13, v1, 3, 1
    v_bfe_u32 v15, v1, 2, 1
    v_xor_b32 v15, v15, v13
    v_lshl_add_u32 v13, v15, 1, v13
    v_lshrrev_b32 v16, 4, v1
    v_xor_b32 v13, v13, v16
    v_and_b32 v17, 15, v1
    v_lshlrev_b32 v17, 6, v17
    s_lshl_b32 s76, s74, 12
    v_add_u32 v17, s76, v17
    v_lshl_add_u32 v5, v13, 4, v17
    v_bfe_u32 v15, v1, 4, 1
    v_bfe_u32 v17, v1, 2, 2
    v_lshl_add_u32 v16, v16, 3, v17
    v_lshlrev_b32 v16, 6, v16
    v_and_b32 v17, 3, v1
    v_lshl_add_u32 v16, v17, 3, v16
    v_add_u32 v16, 32768, v16
    s_mul_i32 s76, s75, 3
    s_add_u32 s77, s76, 0
    s_and_b32 s78, s77, 1
    s_lshr_b32 s77, s77, 1
    s_lshl_b32 s77, s77, 11
    v_xor_b32 v17, s78, v15
    v_lshl_add_u32 v2, v17, 5, v16
    v_add_u32 v2, s77, v2
    s_add_u32 s77, s76, 1
    s_and_b32 s78, s77, 1
    s_lshr_b32 s77, s77, 1
    s_lshl_b32 s77, s77, 11
    v_xor_b32 v17, s78, v15
    v_lshl_add_u32 v3, v17, 5, v16
    v_add_u32 v3, s77, v3
    s_add_u32 s77, s76, 2
    s_and_b32 s78, s77, 1
    s_lshr_b32 s77, s77, 1
    s_lshl_b32 s77, s77, 11
    v_xor_b32 v17, s78, v15
    v_lshl_add_u32 v4, v17, 5, v16
    v_add_u32 v4, s77, v4
    v_mov_b32 v7, v12
    v_add_u32 v8, 4096, v7
    v_bfe_u32 v9, v1, 4, 1
    v_lshlrev_b32 v9, 10, v9
    v_lshl_add_u32 v9, v14, 8, v9
    v_and_b32 v17, 15, v1
    v_lshl_add_u32 v9, v17, 4, v9
    v_mov_b32 v160, 0
    v_mov_b32 v161, 0
    v_mov_b32 v162, 0
    v_mov_b32 v163, 0
    v_mov_b32 v164, 0
    v_mov_b32 v165, 0
    v_mov_b32 v166, 0
    v_mov_b32 v167, 0
    v_mov_b32 v168, 0
    v_mov_b32 v169, 0
    v_mov_b32 v170, 0
    v_mov_b32 v171, 0
    v_mov_b32 v172, 0
    v_mov_b32 v173, 0
    v_mov_b32 v174, 0
    v_mov_b32 v175, 0
    v_mov_b32 v176, 0
    v_mov_b32 v177, 0
    v_mov_b32 v178, 0
    v_mov_b32 v179, 0
    v_mov_b32 v180, 0
    v_mov_b32 v181, 0
    v_mov_b32 v182, 0
    v_mov_b32 v183, 0
    v_mov_b32 v184, 0
    v_mov_b32 v185, 0
    v_mov_b32 v186, 0
    v_mov_b32 v187, 0
    v_mov_b32 v188, 0
    v_mov_b32 v189, 0
    v_mov_b32 v190, 0
    v_mov_b32 v191, 0
    v_mov_b32 v192, 0
    v_mov_b32 v193, 0
    v_mov_b32 v194, 0
    v_mov_b32 v195, 0
    v_mov_b32 v196, 0
    v_mov_b32 v197, 0
    v_mov_b32 v198, 0
    v_mov_b32 v199, 0
    v_mov_b32 v200, 0
    v_mov_b32 v201, 0
    v_mov_b32 v202, 0
    v_mov_b32 v203, 0
    v_mov_b32 v204, 0
    v_mov_b32 v205, 0
    v_mov_b32 v206, 0
    v_mov_b32 v207, 0
    v_mov_b32 v208, 0
    v_mov_b32 v209, 0
    v_mov_b32 v210, 0
    v_mov_b32 v211, 0
    v_mov_b32 v212, 0
    v_mov_b32 v213, 0
    v_mov_b32 v214, 0
    v_mov_b32 v215, 0
    v_mov_b32 v216, 0
    v_mov_b32 v217, 0
    v_mov_b32 v218, 0
    v_mov_b32 v219, 0
    v_mov_b32 v220, 0
    v_mov_b32 v221, 0
    v_mov_b32 v222, 0
    v_mov_b32 v223, 0
    v_mov_b32 v224, 0
    v_mov_b32 v225, 0
    v_mov_b32 v226, 0
    v_mov_b32 v227, 0
    v_mov_b32 v228, 0
    v_mov_b32 v229, 0
    v_mov_b32 v230, 0
    v_mov_b32 v231, 0
    v_mov_b32 v232, 0
    v_mov_b32 v233, 0
    v_mov_b32 v234, 0
    v_mov_b32 v235, 0
    v_mov_b32 v236, 0
    v_mov_b32 v237, 0
    v_mov_b32 v238, 0
    v_mov_b32 v239, 0
    v_mov_b32 v240, 0
    v_mov_b32 v241, 0
    v_mov_b32 v242, 0
    v_mov_b32 v243, 0
    v_mov_b32 v244, 0
    v_mov_b32 v245, 0
    v_mov_b32 v246, 0
    v_mov_b32 v247, 0
    v_mov_b32 v248, 0
    v_mov_b32 v249, 0
    v_mov_b32 v250, 0
    v_mov_b32 v251, 0
    v_mov_b32 v252, 0
    v_mov_b32 v253, 0
    v_mov_b32 v254, 0
    v_mov_b32 v255, 0
    s_mov_b32 s86, 0
    s_waitcnt lgkmcnt(0)
    s_waitcnt lgkmcnt(0)
    s_mov_b32 s44, s42
    s_and_b32 s45, s43, 0xffff
    s_mov_b32 s46, 268435456
    s_mov_b32 s47, 0x20000
    s_cmp_lg_u32 s3, 1
    s_cbranch_scc1 L_ct_24
    s_getpc_b64 s[76:77]
L_pc:
    s_sub_u32 s76, s76, L_pc-gated_mix__ssm_conv_h3__glu_gated_glu__prompt_kernel
    s_subb_u32 s77, s77, 0
    s_mul_i32 s78, s5, 7
    v_add_u32 v50, s78, v1
    v_lshlrev_b32 v50, 7, v50
    v_min_u32 v50, L_codeend-gated_mix__ssm_conv_h3__glu_gated_glu__prompt_kernel-4, v50
    s_mov_b64 exec, 0x7f
    global_load_dword v51, v50, s[76:77]
    s_mov_b64 exec, -1
L_ct_24:
    s_barrier
    v_mul_u32_u24 v90, 3277, v1
    v_lshrrev_b32 v90, 16, v90
    v_mul_u32_u24 v91, 20, v90
    v_sub_u32 v91, v1, v91
    s_mul_i32 s76, s74, 17728
    s_add_u32 s76, s76, 117376
    v_lshlrev_b32 v95, 5, v91
    v_add_u32 v95, s76, v95
    s_mul_i32 s77, s75, 3072
    s_add_u32 s76, s76, s77
    s_and_b32 s77, s10, 1
    s_lshl_b32 s77, s77, 5
    s_add_u32 s76, s76, s77
    v_mul_u32_u24 v10, 1152, v90
    v_lshl_add_u32 v10, v91, 3, v10
    v_add_u32 v10, s76, v10
    s_lshl_b32 s77, s3, 3
    v_mul_u32_u24 v85, 3, v90
    v_add_u32 v85, s77, v85
    v_and_b32 v86, 7, v91
    v_sub_u32 v87, 29, v85
    v_lshrrev_b32 v88, 2, v87
    v_xor_b32 v88, v88, v86
    v_lshlrev_b32 v88, 4, v88
    v_and_b32 v87, 3, v87
    v_lshl_add_u32 v88, v87, 2, v88
    v_lshl_add_u32 v92, v91, 7, v88
    v_add_u32 v92, 81920, v92
    v_sub_u32 v87, 30, v85
    v_lshrrev_b32 v88, 2, v87
    v_xor_b32 v88, v88, v86
    v_lshlrev_b32 v88, 4, v88
    v_and_b32 v87, 3, v87
    v_lshl_add_u32 v88, v87, 2, v88
    v_lshl_add_u32 v93, v91, 7, v88
    v_add_u32 v93, 81920, v93
    v_sub_u32 v87, 31, v85
    v_lshrrev_b32 v88, 2, v87
    v_xor_b32 v88, v88, v86
    v_lshlrev_b32 v88, 4, v88
    v_and_b32 v87, 3, v87
    v_lshl_add_u32 v88, v87, 2, v88
    v_lshl_add_u32 v94, v91, 7, v88
    v_add_u32 v94, 81920, v94
    s_waitcnt vmcnt(0)
    s_barrier
    ds_read_b128 v[36:39], v5 offset:0
    ds_read_b64_tr_b16 v[12:13], v2 offset:0
    ds_read_b64_tr_b16 v[14:15], v2 offset:256
    ds_read_b128 v[40:43], v5 offset:1024
    ds_read_b128 v[44:47], v5 offset:2048
    ds_read_b128 v[48:51], v5 offset:3072
    ds_read_b64_tr_b16 v[16:17], v2 offset:6144
    ds_read_b64_tr_b16 v[18:19], v2 offset:6400
    ds_read_b64_tr_b16 v[20:21], v3 offset:0
    ds_read_b64_tr_b16 v[22:23], v3 offset:256
    ds_read_b64_tr_b16 v[24:25], v3 offset:6144
    ds_read_b64_tr_b16 v[26:27], v3 offset:6400
    ds_read_b64_tr_b16 v[28:29], v4 offset:0
    ds_read_b64_tr_b16 v[30:31], v4 offset:256
    ds_read_b64_tr_b16 v[32:33], v4 offset:6144
    ds_read_b64_tr_b16 v[34:35], v4 offset:6400
    s_waitcnt lgkmcnt(0)
L_g1:
    v_mfma_f32_16x16x32_bf16 v[160:163], v[12:15], v[36:39], v[160:163]
    v_mfma_f32_16x16x32_bf16 v[164:167], v[12:15], v[40:43], v[164:167]
    s_barrier
    ds_read_b128 v[76:79], v5 offset:8192
    v_mfma_f32_16x16x32_bf16 v[176:179], v[12:15], v[44:47], v[176:179]
    ds_read_b64_tr_b16 v[52:53], v2 offset:12288
    v_mfma_f32_16x16x32_bf16 v[180:183], v[12:15], v[48:51], v[180:183]
    ds_read_b64_tr_b16 v[54:55], v2 offset:12544
    v_mfma_f32_16x16x32_bf16 v[168:171], v[16:19], v[36:39], v[168:171]
    ds_read_b128 v[80:83], v5 offset:9216
    v_mfma_f32_16x16x32_bf16 v[172:175], v[16:19], v[40:43], v[172:175]
    ds_read_b128 v[84:87], v5 offset:10240
    v_mfma_f32_16x16x32_bf16 v[184:187], v[16:19], v[44:47], v[184:187]
    ds_read_b128 v[88:91], v5 offset:11264
    v_mfma_f32_16x16x32_bf16 v[188:191], v[16:19], v[48:51], v[188:191]
    ds_read_b64_tr_b16 v[56:57], v2 offset:18432
    v_mfma_f32_16x16x32_bf16 v[192:195], v[20:23], v[36:39], v[192:195]
    ds_read_b64_tr_b16 v[58:59], v2 offset:18688
    v_mfma_f32_16x16x32_bf16 v[196:199], v[20:23], v[40:43], v[196:199]
    ds_read_b64_tr_b16 v[60:61], v3 offset:12288
    v_mfma_f32_16x16x32_bf16 v[208:211], v[20:23], v[44:47], v[208:211]
    ds_read_b64_tr_b16 v[62:63], v3 offset:12544
    v_mfma_f32_16x16x32_bf16 v[212:215], v[20:23], v[48:51], v[212:215]
    ds_read_b64_tr_b16 v[64:65], v3 offset:18432
    v_mfma_f32_16x16x32_bf16 v[200:203], v[24:27], v[36:39], v[200:203]
    ds_read_b64_tr_b16 v[66:67], v3 offset:18688
    v_mfma_f32_16x16x32_bf16 v[204:207], v[24:27], v[40:43], v[204:207]
    ds_read_b64_tr_b16 v[68:69], v4 offset:12288
    v_mfma_f32_16x16x32_bf16 v[216:219], v[24:27], v[44:47], v[216:219]
    ds_read_b64_tr_b16 v[70:71], v4 offset:12544
    v_mfma_f32_16x16x32_bf16 v[220:223], v[24:27], v[48:51], v[220:223]
    ds_read_b64_tr_b16 v[72:73], v4 offset:18432
    v_mfma_f32_16x16x32_bf16 v[224:227], v[28:31], v[36:39], v[224:227]
    ds_read_b64_tr_b16 v[74:75], v4 offset:18688
    v_mfma_f32_16x16x32_bf16 v[228:231], v[28:31], v[40:43], v[228:231]
    v_mfma_f32_16x16x32_bf16 v[240:243], v[28:31], v[44:47], v[240:243]
    v_mfma_f32_16x16x32_bf16 v[244:247], v[28:31], v[48:51], v[244:247]
    v_mfma_f32_16x16x32_bf16 v[232:235], v[32:35], v[36:39], v[232:235]
    v_mfma_f32_16x16x32_bf16 v[236:239], v[32:35], v[40:43], v[236:239]
    v_mfma_f32_16x16x32_bf16 v[248:251], v[32:35], v[44:47], v[248:251]
    v_mfma_f32_16x16x32_bf16 v[252:255], v[32:35], v[48:51], v[252:255]
    s_waitcnt lgkmcnt(0)
    s_cmp_eq_u32 s86, 0
    s_cbranch_scc1 L_kv
L_kvret:
    v_mfma_f32_16x16x32_bf16 v[160:163], v[52:55], v[76:79], v[160:163]
    v_mfma_f32_16x16x32_bf16 v[164:167], v[52:55], v[80:83], v[164:167]
    s_barrier
    ds_read_b128 v[36:39], v5 offset:16384
    v_mfma_f32_16x16x32_bf16 v[176:179], v[52:55], v[84:87], v[176:179]
    ds_read_b64_tr_b16 v[12:13], v2 offset:24576
    v_mfma_f32_16x16x32_bf16 v[180:183], v[52:55], v[88:91], v[180:183]
    ds_read_b64_tr_b16 v[14:15], v2 offset:24832
    v_mfma_f32_16x16x32_bf16 v[168:171], v[56:59], v[76:79], v[168:171]
    ds_read_b128 v[40:43], v5 offset:17408
    v_mfma_f32_16x16x32_bf16 v[172:175], v[56:59], v[80:83], v[172:175]
    ds_read_b128 v[44:47], v5 offset:18432
    v_mfma_f32_16x16x32_bf16 v[184:187], v[56:59], v[84:87], v[184:187]
    ds_read_b128 v[48:51], v5 offset:19456
    v_mfma_f32_16x16x32_bf16 v[188:191], v[56:59], v[88:91], v[188:191]
    ds_read_b64_tr_b16 v[16:17], v2 offset:30720
    v_mfma_f32_16x16x32_bf16 v[192:195], v[60:63], v[76:79], v[192:195]
    ds_read_b64_tr_b16 v[18:19], v2 offset:30976
    v_mfma_f32_16x16x32_bf16 v[196:199], v[60:63], v[80:83], v[196:199]
    ds_read_b64_tr_b16 v[20:21], v3 offset:24576
    v_mfma_f32_16x16x32_bf16 v[208:211], v[60:63], v[84:87], v[208:211]
    ds_read_b64_tr_b16 v[22:23], v3 offset:24832
    v_mfma_f32_16x16x32_bf16 v[212:215], v[60:63], v[88:91], v[212:215]
    ds_read_b64_tr_b16 v[24:25], v3 offset:30720
    v_mfma_f32_16x16x32_bf16 v[200:203], v[64:67], v[76:79], v[200:203]
    ds_read_b64_tr_b16 v[26:27], v3 offset:30976
    v_mfma_f32_16x16x32_bf16 v[204:207], v[64:67], v[80:83], v[204:207]
    ds_read_b64_tr_b16 v[28:29], v4 offset:24576
    v_mfma_f32_16x16x32_bf16 v[216:219], v[64:67], v[84:87], v[216:219]
    ds_read_b64_tr_b16 v[30:31], v4 offset:24832
    v_mfma_f32_16x16x32_bf16 v[220:223], v[64:67], v[88:91], v[220:223]
    ds_read_b64_tr_b16 v[32:33], v4 offset:30720
    v_mfma_f32_16x16x32_bf16 v[224:227], v[68:71], v[76:79], v[224:227]
    ds_read_b64_tr_b16 v[34:35], v4 offset:30976
    v_mfma_f32_16x16x32_bf16 v[228:231], v[68:71], v[80:83], v[228:231]
    v_mfma_f32_16x16x32_bf16 v[240:243], v[68:71], v[84:87], v[240:243]
    v_mfma_f32_16x16x32_bf16 v[244:247], v[68:71], v[88:91], v[244:247]
    v_mfma_f32_16x16x32_bf16 v[232:235], v[72:75], v[76:79], v[232:235]
    v_mfma_f32_16x16x32_bf16 v[236:239], v[72:75], v[80:83], v[236:239]
    v_mfma_f32_16x16x32_bf16 v[248:251], v[72:75], v[84:87], v[248:251]
    v_mfma_f32_16x16x32_bf16 v[252:255], v[72:75], v[88:91], v[252:255]
    s_waitcnt lgkmcnt(0)
    v_mfma_f32_16x16x32_bf16 v[160:163], v[12:15], v[36:39], v[160:163]
    v_mfma_f32_16x16x32_bf16 v[164:167], v[12:15], v[40:43], v[164:167]
    s_barrier
    ds_read_b128 v[76:79], v5 offset:24576
    v_mfma_f32_16x16x32_bf16 v[176:179], v[12:15], v[44:47], v[176:179]
    ds_read_b64_tr_b16 v[52:53], v2 offset:36864
    v_mfma_f32_16x16x32_bf16 v[180:183], v[12:15], v[48:51], v[180:183]
    ds_read_b64_tr_b16 v[54:55], v2 offset:37120
    v_mfma_f32_16x16x32_bf16 v[168:171], v[16:19], v[36:39], v[168:171]
    ds_read_b128 v[80:83], v5 offset:25600
    v_mfma_f32_16x16x32_bf16 v[172:175], v[16:19], v[40:43], v[172:175]
    ds_read_b128 v[84:87], v5 offset:26624
    v_mfma_f32_16x16x32_bf16 v[184:187], v[16:19], v[44:47], v[184:187]
    ds_read_b128 v[88:91], v5 offset:27648
    v_mfma_f32_16x16x32_bf16 v[188:191], v[16:19], v[48:51], v[188:191]
    ds_read_b64_tr_b16 v[56:57], v2 offset:43008
    v_mfma_f32_16x16x32_bf16 v[192:195], v[20:23], v[36:39], v[192:195]
    ds_read_b64_tr_b16 v[58:59], v2 offset:43264
    v_mfma_f32_16x16x32_bf16 v[196:199], v[20:23], v[40:43], v[196:199]
    ds_read_b64_tr_b16 v[60:61], v3 offset:36864
    v_mfma_f32_16x16x32_bf16 v[208:211], v[20:23], v[44:47], v[208:211]
    ds_read_b64_tr_b16 v[62:63], v3 offset:37120
    v_mfma_f32_16x16x32_bf16 v[212:215], v[20:23], v[48:51], v[212:215]
    ds_read_b64_tr_b16 v[64:65], v3 offset:43008
    v_mfma_f32_16x16x32_bf16 v[200:203], v[24:27], v[36:39], v[200:203]
    ds_read_b64_tr_b16 v[66:67], v3 offset:43264
    v_mfma_f32_16x16x32_bf16 v[204:207], v[24:27], v[40:43], v[204:207]
    ds_read_b64_tr_b16 v[68:69], v4 offset:36864
    v_mfma_f32_16x16x32_bf16 v[216:219], v[24:27], v[44:47], v[216:219]
    ds_read_b64_tr_b16 v[70:71], v4 offset:37120
    v_mfma_f32_16x16x32_bf16 v[220:223], v[24:27], v[48:51], v[220:223]
    ds_read_b64_tr_b16 v[72:73], v4 offset:43008
    v_mfma_f32_16x16x32_bf16 v[224:227], v[28:31], v[36:39], v[224:227]
    ds_read_b64_tr_b16 v[74:75], v4 offset:43264
    v_mfma_f32_16x16x32_bf16 v[228:231], v[28:31], v[40:43], v[228:231]
    v_mfma_f32_16x16x32_bf16 v[240:243], v[28:31], v[44:47], v[240:243]
    v_mfma_f32_16x16x32_bf16 v[244:247], v[28:31], v[48:51], v[244:247]
    v_mfma_f32_16x16x32_bf16 v[232:235], v[32:35], v[36:39], v[232:235]
    v_mfma_f32_16x16x32_bf16 v[236:239], v[32:35], v[40:43], v[236:239]
    v_mfma_f32_16x16x32_bf16 v[248:251], v[32:35], v[44:47], v[248:251]
    v_mfma_f32_16x16x32_bf16 v[252:255], v[32:35], v[48:51], v[252:255]
    s_waitcnt lgkmcnt(0)
    v_mfma_f32_16x16x32_bf16 v[160:163], v[52:55], v[76:79], v[160:163]
    v_mfma_f32_16x16x32_bf16 v[164:167], v[52:55], v[80:83], v[164:167]
    s_cmp_eq_u32 s86, 16
    s_cbranch_scc1 L_nb_25
    s_barrier
L_nb_25:
    ds_read_b128 v[36:39], v5 offset:0
    v_mfma_f32_16x16x32_bf16 v[176:179], v[52:55], v[84:87], v[176:179]
    ds_read_b64_tr_b16 v[12:13], v2 offset:0
    v_mfma_f32_16x16x32_bf16 v[180:183], v[52:55], v[88:91], v[180:183]
    ds_read_b64_tr_b16 v[14:15], v2 offset:256
    v_mfma_f32_16x16x32_bf16 v[168:171], v[56:59], v[76:79], v[168:171]
    ds_read_b128 v[40:43], v5 offset:1024
    v_mfma_f32_16x16x32_bf16 v[172:175], v[56:59], v[80:83], v[172:175]
    ds_read_b128 v[44:47], v5 offset:2048
    v_mfma_f32_16x16x32_bf16 v[184:187], v[56:59], v[84:87], v[184:187]
    ds_read_b128 v[48:51], v5 offset:3072
    v_mfma_f32_16x16x32_bf16 v[188:191], v[56:59], v[88:91], v[188:191]
    ds_read_b64_tr_b16 v[16:17], v2 offset:6144
    v_mfma_f32_16x16x32_bf16 v[192:195], v[60:63], v[76:79], v[192:195]
    ds_read_b64_tr_b16 v[18:19], v2 offset:6400
    v_mfma_f32_16x16x32_bf16 v[196:199], v[60:63], v[80:83], v[196:199]
    ds_read_b64_tr_b16 v[20:21], v3 offset:0
    v_mfma_f32_16x16x32_bf16 v[208:211], v[60:63], v[84:87], v[208:211]
    ds_read_b64_tr_b16 v[22:23], v3 offset:256
    v_mfma_f32_16x16x32_bf16 v[212:215], v[60:63], v[88:91], v[212:215]
    ds_read_b64_tr_b16 v[24:25], v3 offset:6144
    v_mfma_f32_16x16x32_bf16 v[200:203], v[64:67], v[76:79], v[200:203]
    ds_read_b64_tr_b16 v[26:27], v3 offset:6400
    v_mfma_f32_16x16x32_bf16 v[204:207], v[64:67], v[80:83], v[204:207]
    ds_read_b64_tr_b16 v[28:29], v4 offset:0
    v_mfma_f32_16x16x32_bf16 v[216:219], v[64:67], v[84:87], v[216:219]
    ds_read_b64_tr_b16 v[30:31], v4 offset:256
    v_mfma_f32_16x16x32_bf16 v[220:223], v[64:67], v[88:91], v[220:223]
    ds_read_b64_tr_b16 v[32:33], v4 offset:6144
    v_mfma_f32_16x16x32_bf16 v[224:227], v[68:71], v[76:79], v[224:227]
    ds_read_b64_tr_b16 v[34:35], v4 offset:6400
    v_mfma_f32_16x16x32_bf16 v[228:231], v[68:71], v[80:83], v[228:231]
    v_mfma_f32_16x16x32_bf16 v[240:243], v[68:71], v[84:87], v[240:243]
    v_mfma_f32_16x16x32_bf16 v[244:247], v[68:71], v[88:91], v[244:247]
    v_mfma_f32_16x16x32_bf16 v[232:235], v[72:75], v[76:79], v[232:235]
    v_mfma_f32_16x16x32_bf16 v[236:239], v[72:75], v[80:83], v[236:239]
    v_mfma_f32_16x16x32_bf16 v[248:251], v[72:75], v[84:87], v[248:251]
    v_mfma_f32_16x16x32_bf16 v[252:255], v[72:75], v[88:91], v[252:255]
    s_waitcnt lgkmcnt(0)
    s_add_u32 s86, s86, 4
    s_cmp_lt_u32 s86, 20
    s_cbranch_scc1 L_g1
    v_mov_b32 v116, 163104
    v_mov_b32 v117, 1
    s_mov_b64 exec, 1
    ds_add_u32 v116, v117 offset:20
    s_mov_b64 exec, -1
    ds_read_b128 v[116:119], v116
    s_waitcnt lgkmcnt(0)
    v_readfirstlane_b32 s72, v116
    v_readfirstlane_b32 s73, v117
    v_readfirstlane_b32 s76, v119
    s_nop 1
    s_cmp_lg_u32 s76, 0
    s_cbranch_scc1 L_faok_26
    v_lshlrev_b32 v114, 3, v1
    s_lshl_b32 s76, s10, 9
    s_add_u32 s76, s76, 14745600
    s_mov_b32 s94, 30000
L_poll_27:
    buffer_load_dwordx2 v[112:113], v114, s[44:47], s76 offen sc1
    s_waitcnt vmcnt(0)
    v_cmp_ne_u64 vcc, s[72:73], v[112:113]
    s_nop 1
    s_cbranch_vccz L_pdone_28
    s_sleep 4
    s_sub_u32 s94, s94, 1
    s_cbranch_scc0 L_poll_27
L_pdone_28:
L_faok_26:
    s_mul_i32 s78, s11, 3
    s_lshr_b32 s78, s78, 1
    s_mul_i32 s79, s12, 3
    s_add_u32 s78, s78, s79
    s_cmp_ge_u32 s78, 12
    s_cselect_b32 s79, 12, 0
    s_sub_u32 s78, s78, s79
    s_mul_i32 s79, s3, 12
    s_mul_i32 s80, s10, 245888
    s_add_u32 s80, s80, 6356992
    s_mul_i32 s81, s9, 196736
    s_add_u32 s81, s81, 0
    s_mul_i32 s92, s3, 20480
    s_mov_b32 s84, 0xbfb8aa3b
    s_mov_b32 s85, 0xbfb8aa3b
    s_lshl_b32 s87, s6, 1
    s_add_u32 s87, s87, s74
    s_mul_i32 s88, s87, 196736
    s_mul_i32 s89, s7, 6
    s_mul_i32 s90, s75, 3
    s_add_u32 s89, s89, s90
    s_add_u32 s90, s89, 0
    s_and_b32 s91, s90, 1
    s_lshr_b32 s90, s90, 1
    s_lshl_b32 s90, s90, 12
    s_lshl_b32 s91, s91, 9
    s_add_u32 s90, s90, s91
    s_add_u32 s90, s90, s88
    v_pk_mul_f32 v[160:161], v[160:161], s[84:85]
    v_pk_mul_f32 v[162:163], v[162:163], s[84:85]
    v_pk_mul_f32 v[164:165], v[164:165], s[84:85]
    v_pk_mul_f32 v[166:167], v[166:167], s[84:85]
    v_exp_f32 v160, v160
    v_exp_f32 v161, v161
    v_exp_f32 v162, v162
    v_exp_f32 v163, v163
    v_exp_f32 v164, v164
    v_exp_f32 v165, v165
    v_exp_f32 v166, v166
    v_exp_f32 v167, v167
    v_pk_add_f32 v[160:161], v[160:161], 1.0 op_sel_hi:[1,0]
    v_pk_add_f32 v[162:163], v[162:163], 1.0 op_sel_hi:[1,0]
    v_pk_add_f32 v[164:165], v[164:165], 1.0 op_sel_hi:[1,0]
    v_pk_add_f32 v[166:167], v[166:167], 1.0 op_sel_hi:[1,0]
    v_rcp_f32 v160, v160
    v_rcp_f32 v161, v161
    v_rcp_f32 v162, v162
    v_rcp_f32 v163, v163
    v_rcp_f32 v164, v164
    v_rcp_f32 v165, v165
    v_rcp_f32 v166, v166
    v_rcp_f32 v167, v167
    v_pk_mul_f32 v[160:161], v[160:161], v[168:169]
    v_pk_mul_f32 v[162:163], v[162:163], v[170:171]
    v_pk_mul_f32 v[164:165], v[164:165], v[172:173]
    v_pk_mul_f32 v[166:167], v[166:167], v[174:175]
    v_cvt_pk_bf16_f32 v120, v160, v161
    v_cvt_pk_bf16_f32 v121, v162, v163
    v_cvt_pk_bf16_f32 v122, v164, v165
    v_cvt_pk_bf16_f32 v123, v166, v167
    s_nop 1
    v_permlane16_swap_b32 v120, v122
    v_permlane16_swap_b32 v121, v123
    buffer_store_dwordx4 v[120:123], v9, s[44:47], s90 offen offset:0 sc1
    s_add_u32 s98, s78, 0
    s_cmp_ge_u32 s98, 12
    s_cselect_b32 s82, 12, 0
    s_sub_u32 s98, s98, s82
    s_add_u32 s98, s98, s79
    s_mul_i32 s98, s98, 5120
    s_add_u32 s98, s98, s80
    buffer_load_dwordx4 v[12:15], v7, s[44:47], s98 offen offset:0 sc1
    v_pk_mul_f32 v[176:177], v[176:177], s[84:85]
    v_pk_mul_f32 v[178:179], v[178:179], s[84:85]
    v_pk_mul_f32 v[180:181], v[180:181], s[84:85]
    v_pk_mul_f32 v[182:183], v[182:183], s[84:85]
    v_exp_f32 v176, v176
    v_exp_f32 v177, v177
    v_exp_f32 v178, v178
    v_exp_f32 v179, v179
    v_exp_f32 v180, v180
    v_exp_f32 v181, v181
    v_exp_f32 v182, v182
    v_exp_f32 v183, v183
    v_pk_add_f32 v[176:177], v[176:177], 1.0 op_sel_hi:[1,0]
    v_pk_add_f32 v[178:179], v[178:179], 1.0 op_sel_hi:[1,0]
    v_pk_add_f32 v[180:181], v[180:181], 1.0 op_sel_hi:[1,0]
    v_pk_add_f32 v[182:183], v[182:183], 1.0 op_sel_hi:[1,0]
    v_rcp_f32 v176, v176
    v_rcp_f32 v177, v177
    v_rcp_f32 v178, v178
    v_rcp_f32 v179, v179
    v_rcp_f32 v180, v180
    v_rcp_f32 v181, v181
    v_rcp_f32 v182, v182
    v_rcp_f32 v183, v183
    v_pk_mul_f32 v[176:177], v[176:177], v[184:185]
    v_pk_mul_f32 v[178:179], v[178:179], v[186:187]
    v_pk_mul_f32 v[180:181], v[180:181], v[188:189]
    v_pk_mul_f32 v[182:183], v[182:183], v[190:191]
    v_cvt_pk_bf16_f32 v124, v176, v177
    v_cvt_pk_bf16_f32 v125, v178, v179
    v_cvt_pk_bf16_f32 v126, v180, v181
    v_cvt_pk_bf16_f32 v127, v182, v183
    s_nop 1
    v_permlane16_swap_b32 v124, v126
    v_permlane16_swap_b32 v125, v127
    buffer_store_dwordx4 v[124:127], v9, s[44:47], s90 offen offset:2048 sc1
    buffer_load_dwordx4 v[16:19], v7, s[44:47], s98 offen offset:1024 sc1
    s_add_u32 s90, s89, 1
    s_and_b32 s91, s90, 1
    s_lshr_b32 s90, s90, 1
    s_lshl_b32 s90, s90, 12
    s_lshl_b32 s91, s91, 9
    s_add_u32 s90, s90, s91
    s_add_u32 s90, s90, s88
    v_pk_mul_f32 v[192:193], v[192:193], s[84:85]
    v_pk_mul_f32 v[194:195], v[194:195], s[84:85]
    v_pk_mul_f32 v[196:197], v[196:197], s[84:85]
    v_pk_mul_f32 v[198:199], v[198:199], s[84:85]
    v_exp_f32 v192, v192
    v_exp_f32 v193, v193
    v_exp_f32 v194, v194
    v_exp_f32 v195, v195
    v_exp_f32 v196, v196
    v_exp_f32 v197, v197
    v_exp_f32 v198, v198
    v_exp_f32 v199, v199
    v_pk_add_f32 v[192:193], v[192:193], 1.0 op_sel_hi:[1,0]
    v_pk_add_f32 v[194:195], v[194:195], 1.0 op_sel_hi:[1,0]
    v_pk_add_f32 v[196:197], v[196:197], 1.0 op_sel_hi:[1,0]
    v_pk_add_f32 v[198:199], v[198:199], 1.0 op_sel_hi:[1,0]
    v_rcp_f32 v192, v192
    v_rcp_f32 v193, v193
    v_rcp_f32 v194, v194
    v_rcp_f32 v195, v195
    v_rcp_f32 v196, v196
    v_rcp_f32 v197, v197
    v_rcp_f32 v198, v198
    v_rcp_f32 v199, v199
    v_pk_mul_f32 v[192:193], v[192:193], v[200:201]
    v_pk_mul_f32 v[194:195], v[194:195], v[202:203]
    v_pk_mul_f32 v[196:197], v[196:197], v[204:205]
    v_pk_mul_f32 v[198:199], v[198:199], v[206:207]
    v_cvt_pk_bf16_f32 v128, v192, v193
    v_cvt_pk_bf16_f32 v129, v194, v195
    v_cvt_pk_bf16_f32 v130, v196, v197
    v_cvt_pk_bf16_f32 v131, v198, v199
    s_nop 1
    v_permlane16_swap_b32 v128, v130
    v_permlane16_swap_b32 v129, v131
    buffer_store_dwordx4 v[128:131], v9, s[44:47], s90 offen offset:0 sc1
    buffer_load_dwordx4 v[20:23], v7, s[44:47], s98 offen offset:2048 sc1
    v_pk_mul_f32 v[208:209], v[208:209], s[84:85]
    v_pk_mul_f32 v[210:211], v[210:211], s[84:85]
    v_pk_mul_f32 v[212:213], v[212:213], s[84:85]
    v_pk_mul_f32 v[214:215], v[214:215], s[84:85]
    v_exp_f32 v208, v208
    v_exp_f32 v209, v209
    v_exp_f32 v210, v210
    v_exp_f32 v211, v211
    v_exp_f32 v212, v212
    v_exp_f32 v213, v213
    v_exp_f32 v214, v214
    v_exp_f32 v215, v215
    v_pk_add_f32 v[208:209], v[208:209], 1.0 op_sel_hi:[1,0]
    v_pk_add_f32 v[210:211], v[210:211], 1.0 op_sel_hi:[1,0]
    v_pk_add_f32 v[212:213], v[212:213], 1.0 op_sel_hi:[1,0]
    v_pk_add_f32 v[214:215], v[214:215], 1.0 op_sel_hi:[1,0]
    v_rcp_f32 v208, v208
    v_rcp_f32 v209, v209
    v_rcp_f32 v210, v210
    v_rcp_f32 v211, v211
    v_rcp_f32 v212, v212
    v_rcp_f32 v213, v213
    v_rcp_f32 v214, v214
    v_rcp_f32 v215, v215
    v_pk_mul_f32 v[208:209], v[208:209], v[216:217]
    v_pk_mul_f32 v[210:211], v[210:211], v[218:219]
    v_pk_mul_f32 v[212:213], v[212:213], v[220:221]
    v_pk_mul_f32 v[214:215], v[214:215], v[222:223]
    v_cvt_pk_bf16_f32 v132, v208, v209
    v_cvt_pk_bf16_f32 v133, v210, v211
    v_cvt_pk_bf16_f32 v134, v212, v213
    v_cvt_pk_bf16_f32 v135, v214, v215
    s_nop 1
    v_permlane16_swap_b32 v132, v134
    v_permlane16_swap_b32 v133, v135
    buffer_store_dwordx4 v[132:135], v9, s[44:47], s90 offen offset:2048 sc1
    buffer_load_dwordx4 v[24:27], v7, s[44:47], s98 offen offset:3072 sc1
    s_add_u32 s90, s89, 2
    s_and_b32 s91, s90, 1
    s_lshr_b32 s90, s90, 1
    s_lshl_b32 s90, s90, 12
    s_lshl_b32 s91, s91, 9
    s_add_u32 s90, s90, s91
    s_add_u32 s90, s90, s88
    v_pk_mul_f32 v[224:225], v[224:225], s[84:85]
    v_pk_mul_f32 v[226:227], v[226:227], s[84:85]
    v_pk_mul_f32 v[228:229], v[228:229], s[84:85]
    v_pk_mul_f32 v[230:231], v[230:231], s[84:85]
    v_exp_f32 v224, v224
    v_exp_f32 v225, v225
    v_exp_f32 v226, v226
    v_exp_f32 v227, v227
    v_exp_f32 v228, v228
    v_exp_f32 v229, v229
    v_exp_f32 v230, v230
    v_exp_f32 v231, v231
    v_pk_add_f32 v[224:225], v[224:225], 1.0 op_sel_hi:[1,0]
    v_pk_add_f32 v[226:227], v[226:227], 1.0 op_sel_hi:[1,0]
    v_pk_add_f32 v[228:229], v[228:229], 1.0 op_sel_hi:[1,0]
    v_pk_add_f32 v[230:231], v[230:231], 1.0 op_sel_hi:[1,0]
    v_rcp_f32 v224, v224
    v_rcp_f32 v225, v225
    v_rcp_f32 v226, v226
    v_rcp_f32 v227, v227
    v_rcp_f32 v228, v228
    v_rcp_f32 v229, v229
    v_rcp_f32 v230, v230
    v_rcp_f32 v231, v231
    v_pk_mul_f32 v[224:225], v[224:225], v[232:233]
    v_pk_mul_f32 v[226:227], v[226:227], v[234:235]
    v_pk_mul_f32 v[228:229], v[228:229], v[236:237]
    v_pk_mul_f32 v[230:231], v[230:231], v[238:239]
    v_cvt_pk_bf16_f32 v136, v224, v225
    v_cvt_pk_bf16_f32 v137, v226, v227
    v_cvt_pk_bf16_f32 v138, v228, v229
    v_cvt_pk_bf16_f32 v139, v230, v231
    s_nop 1
    v_permlane16_swap_b32 v136, v138
    v_permlane16_swap_b32 v137, v139
    buffer_store_dwordx4 v[136:139], v9, s[44:47], s90 offen offset:0 sc1
    buffer_load_dwordx4 v[28:31], v8, s[44:47], s98 offen sc1
    v_pk_mul_f32 v[240:241], v[240:241], s[84:85]
    v_pk_mul_f32 v[242:243], v[242:243], s[84:85]
    v_pk_mul_f32 v[244:245], v[244:245], s[84:85]
    v_pk_mul_f32 v[246:247], v[246:247], s[84:85]
    v_exp_f32 v240, v240
    v_exp_f32 v241, v241
    v_exp_f32 v242, v242
    v_exp_f32 v243, v243
    v_exp_f32 v244, v244
    v_exp_f32 v245, v245
    v_exp_f32 v246, v246
    v_exp_f32 v247, v247
    v_pk_add_f32 v[240:241], v[240:241], 1.0 op_sel_hi:[1,0]
    v_pk_add_f32 v[242:243], v[242:243], 1.0 op_sel_hi:[1,0]
    v_pk_add_f32 v[244:245], v[244:245], 1.0 op_sel_hi:[1,0]
    v_pk_add_f32 v[246:247], v[246:247], 1.0 op_sel_hi:[1,0]
    v_rcp_f32 v240, v240
    v_rcp_f32 v241, v241
    v_rcp_f32 v242, v242
    v_rcp_f32 v243, v243
    v_rcp_f32 v244, v244
    v_rcp_f32 v245, v245
    v_rcp_f32 v246, v246
    v_rcp_f32 v247, v247
    v_pk_mul_f32 v[240:241], v[240:241], v[248:249]
    v_pk_mul_f32 v[242:243], v[242:243], v[250:251]
    v_pk_mul_f32 v[244:245], v[244:245], v[252:253]
    v_pk_mul_f32 v[246:247], v[246:247], v[254:255]
    v_cvt_pk_bf16_f32 v140, v240, v241
    v_cvt_pk_bf16_f32 v141, v242, v243
    v_cvt_pk_bf16_f32 v142, v244, v245
    v_cvt_pk_bf16_f32 v143, v246, v247
    s_nop 1
    v_permlane16_swap_b32 v140, v142
    v_permlane16_swap_b32 v141, v143
    buffer_store_dwordx4 v[140:143], v9, s[44:47], s90 offen offset:2048 sc1
    s_setprio 0
    s_add_u32 s98, s78, 3
    s_cmp_ge_u32 s98, 12
    s_cselect_b32 s82, 12, 0
    s_sub_u32 s98, s98, s82
    s_add_u32 s98, s98, s79
    s_mul_i32 s98, s98, 5120
    s_add_u32 s98, s98, s80
    buffer_load_dwordx4 v[32:35], v7, s[44:47], s98 offen offset:0 sc1
    buffer_load_dwordx4 v[36:39], v7, s[44:47], s98 offen offset:1024 sc1
    buffer_load_dwordx4 v[40:43], v7, s[44:47], s98 offen offset:2048 sc1
    buffer_load_dwordx4 v[44:47], v7, s[44:47], s98 offen offset:3072 sc1
    s_waitcnt vmcnt(4)
    s_lshl_b32 s90, s87, 8
    s_lshl_b32 s91, s7, 4
    s_add_u32 s90, s90, s91
    s_lshl_b32 s91, s75, 3
    s_add_u32 s90, s90, s91
    s_add_u32 s90, s90, 14761984
    v_mov_b32 v144, s72
    v_mov_b32 v145, s73
    v_mov_b32 v146, 0
    s_mov_b64 exec, 1
    buffer_store_dwordx2 v[144:145], v146, s[44:47], s90 offen sc1
    s_mov_b64 exec, -1
    v_mov_b32 v2, 163132
    v_mov_b32 v3, 1
    ds_write_b32 v2, v3
    buffer_load_dwordx4 v[48:51], v8, s[44:47], s98 offen sc1
    s_add_u32 s98, s78, 6
    s_cmp_ge_u32 s98, 12
    s_cselect_b32 s82, 12, 0
    s_sub_u32 s98, s98, s82
    s_add_u32 s98, s98, s79
    s_mul_i32 s98, s98, 5120
    s_add_u32 s98, s98, s80
    buffer_load_dwordx4 v[52:55], v7, s[44:47], s98 offen offset:0 sc1
    buffer_load_dwordx4 v[56:59], v7, s[44:47], s98 offen offset:1024 sc1
    buffer_load_dwordx4 v[60:63], v7, s[44:47], s98 offen offset:2048 sc1
    buffer_load_dwordx4 v[64:67], v7, s[44:47], s98 offen offset:3072 sc1
    buffer_load_dwordx4 v[68:71], v8, s[44:47], s98 offen sc1
    s_add_u32 s98, s78, 9
    s_cmp_ge_u32 s98, 12
    s_cselect_b32 s82, 12, 0
    s_sub_u32 s98, s98, s82
    s_add_u32 s98, s98, s79
    s_mul_i32 s98, s98, 5120
    s_add_u32 s98, s98, s80
    buffer_load_dwordx4 v[72:75], v7, s[44:47], s98 offen offset:0 sc1
    buffer_load_dwordx4 v[76:79], v7, s[44:47], s98 offen offset:1024 sc1
    buffer_load_dwordx4 v[80:83], v7, s[44:47], s98 offen offset:2048 sc1
    buffer_load_dwordx4 v[84:87], v7, s[44:47], s98 offen offset:3072 sc1
    buffer_load_dwordx4 v[88:91], v8, s[44:47], s98 offen sc1
    s_add_u32 s98, s78, 1
    s_cmp_ge_u32 s98, 12
    s_cselect_b32 s82, 12, 0
    s_sub_u32 s98, s98, s82
    s_add_u32 s98, s98, s79
    s_mul_i32 s98, s98, 5120
    s_add_u32 s98, s98, s80
    buffer_load_dwordx4 v[92:95], v7, s[44:47], s98 offen offset:0 sc1
    buffer_load_dwordx4 v[96:99], v7, s[44:47], s98 offen offset:1024 sc1
    buffer_load_dwordx4 v[100:103], v7, s[44:47], s98 offen offset:2048 sc1
    buffer_load_dwordx4 v[104:107], v7, s[44:47], s98 offen offset:3072 sc1
    buffer_load_dwordx4 v[108:111], v8, s[44:47], s98 offen sc1
    s_mov_b32 s94, 240000
    v_mov_b32 v152, 163124
L_lw_29:
    ds_read_b32 v148, v152
    s_waitcnt lgkmcnt(0)
    s_nop 0
    v_readfirstlane_b32 s95, v148
    s_nop 1
    s_cmp_ge_u32 s95, 4
    s_cbranch_scc1 L_lwd_30
    s_sub_u32 s94, s94, 1
    s_cbranch_scc0 L_lw_29
L_lwd_30:
    v_min_u32 v114, 7, v1
    v_lshlrev_b32 v114, 3, v114
    s_lshl_b32 s90, s9, 8
    s_lshl_b32 s91, s3, 6
    s_add_u32 s90, s90, s91
    s_add_u32 s90, s90, 14761984
    s_add_u32 s83, s78, 4
    s_cmp_ge_u32 s83, 12
    s_cselect_b32 s82, 12, 0
    s_sub_u32 s83, s83, s82
    s_add_u32 s83, s83, s79
    s_mul_i32 s83, s83, 5120
    s_add_u32 s83, s83, s80
    s_add_u32 m0, s92, 0
    s_nop 0
    buffer_load_dwordx4 v7, s[44:47], s83 offen offset:0 sc1 lds
    buffer_load_dwordx4 v7, s[44:47], s83 offen offset:1024 sc1 lds
    buffer_load_dwordx4 v7, s[44:47], s83 offen offset:2048 sc1 lds
    buffer_load_dwordx4 v7, s[44:47], s83 offen offset:3072 sc1 lds
    s_add_u32 m0, s92, 4096
    s_nop 0
    buffer_load_dwordx4 v8, s[44:47], s83 offen sc1 lds
    s_add_u32 s83, s78, 7
    s_cmp_ge_u32 s83, 12
    s_cselect_b32 s82, 12, 0
    s_sub_u32 s83, s83, s82
    s_add_u32 s83, s83, s79
    s_mul_i32 s83, s83, 5120
    s_add_u32 s83, s83, s80
    s_add_u32 m0, s92, 5120
    s_nop 0
    buffer_load_dwordx4 v7, s[44:47], s83 offen offset:0 sc1 lds
    buffer_load_dwordx4 v7, s[44:47], s83 offen offset:1024 sc1 lds
    buffer_load_dwordx4 v7, s[44:47], s83 offen offset:2048 sc1 lds
    buffer_load_dwordx4 v7, s[44:47], s83 offen offset:3072 sc1 lds
    s_add_u32 m0, s92, 9216
    s_nop 0
    buffer_load_dwordx4 v8, s[44:47], s83 offen sc1 lds
    buffer_load_dwordx2 v[148:149], v114, s[44:47], s90 offen sc1
    s_add_u32 s83, s78, 10
    s_cmp_ge_u32 s83, 12
    s_cselect_b32 s82, 12, 0
    s_sub_u32 s83, s83, s82
    s_add_u32 s83, s83, s79
    s_mul_i32 s83, s83, 5120
    s_add_u32 s83, s83, s80
    s_add_u32 m0, s92, 10240
    s_nop 0
    buffer_load_dwordx4 v7, s[44:47], s83 offen offset:0 sc1 lds
    buffer_load_dwordx4 v7, s[44:47], s83 offen offset:1024 sc1 lds
    buffer_load_dwordx4 v7, s[44:47], s83 offen offset:2048 sc1 lds
    buffer_load_dwordx4 v7, s[44:47], s83 offen offset:3072 sc1 lds
    s_add_u32 m0, s92, 14336
    s_nop 0
    buffer_load_dwordx4 v8, s[44:47], s83 offen sc1 lds
    s_add_u32 s83, s78, 2
    s_cmp_ge_u32 s83, 12
    s_cselect_b32 s82, 12, 0
    s_sub_u32 s83, s83, s82
    s_add_u32 s83, s83, s79
    s_mul_i32 s83, s83, 5120
    s_add_u32 s83, s83, s80
    s_add_u32 m0, s92, 15360
    s_nop 0
    buffer_load_dwordx4 v7, s[44:47], s83 offen offset:0 sc1 lds
    buffer_load_dwordx4 v7, s[44:47], s83 offen offset:1024 sc1 lds
    buffer_load_dwordx4 v7, s[44:47], s83 offen offset:2048 sc1 lds
    buffer_load_dwordx4 v7, s[44:47], s83 offen offset:3072 sc1 lds
    s_add_u32 m0, s92, 19456
    s_nop 0
    buffer_load_dwordx4 v8, s[44:47], s83 offen sc1 lds
    v_add_u32 v10, s92, v7
    s_waitcnt vmcnt(10)
    v_cmp_ne_u64 vcc, s[72:73], v[148:149]
    s_nop 1
    s_cbranch_vccz L_go_31
    s_mov_b32 s94, 30000
L_poll_32:
    buffer_load_dwordx2 v[112:113], v114, s[44:47], s90 offen sc1
    s_waitcnt vmcnt(0)
    v_cmp_ne_u64 vcc, s[72:73], v[112:113]
    s_nop 1
    s_cbranch_vccz L_pdone_33
    s_sleep 4
    s_sub_u32 s94, s94, 1
    s_cbranch_scc0 L_poll_32
L_pdone_33:
L_go_31:
    s_add_u32 s83, s78, 0
    s_cmp_ge_u32 s83, 12
    s_cselect_b32 s82, 12, 0
    s_sub_u32 s83, s83, s82
    s_add_u32 s83, s83, s79
    s_lshl_b32 s83, s83, 12
    s_add_u32 s83, s83, s81
    buffer_load_dwordx4 v[112:115], v7, s[44:47], s83 offen offset:0 sc1
    buffer_load_dwordx4 v[116:119], v7, s[44:47], s83 offen offset:1024 sc1
    buffer_load_dwordx4 v[120:123], v7, s[44:47], s83 offen offset:2048 sc1
    buffer_load_dwordx4 v[124:127], v7, s[44:47], s83 offen offset:3072 sc1
    s_waitcnt vmcnt(0)
    s_add_u32 s83, s78, 3
    s_cmp_ge_u32 s83, 12
    s_cselect_b32 s82, 12, 0
    s_sub_u32 s83, s83, s82
    s_add_u32 s83, s83, s79
    s_lshl_b32 s83, s83, 12
    s_add_u32 s83, s83, s81
    buffer_load_dwordx4 v[128:131], v7, s[44:47], s83 offen offset:0 sc1
    buffer_load_dwordx4 v[132:135], v7, s[44:47], s83 offen offset:1024 sc1
    buffer_load_dwordx4 v[136:139], v7, s[44:47], s83 offen offset:2048 sc1
    buffer_load_dwordx4 v[140:143], v7, s[44:47], s83 offen offset:3072 sc1
    s_add_u32 s83, s78, 6
    s_cmp_ge_u32 s83, 12
    s_cselect_b32 s82, 12, 0
    s_sub_u32 s83, s83, s82
    s_add_u32 s83, s83, s79
    s_lshl_b32 s83, s83, 12
    s_add_u32 s83, s83, s81
    buffer_load_dwordx4 v[144:147], v7, s[44:47], s83 offen offset:0 sc1
    buffer_load_dwordx4 v[148:151], v7, s[44:47], s83 offen offset:1024 sc1
    buffer_load_dwordx4 v[152:155], v7, s[44:47], s83 offen offset:2048 sc1
    buffer_load_dwordx4 v[156:159], v7, s[44:47], s83 offen offset:3072 sc1
    s_add_u32 s83, s78, 9
    s_cmp_ge_u32 s83, 12
    s_cselect_b32 s82, 12, 0
    s_sub_u32 s83, s83, s82
    s_add_u32 s83, s83, s79
    s_lshl_b32 s83, s83, 12
    s_add_u32 s83, s83, s81
    buffer_load_dwordx4 v[160:163], v7, s[44:47], s83 offen offset:0 sc1
    buffer_load_dwordx4 v[164:167], v7, s[44:47], s83 offen offset:1024 sc1
    buffer_load_dwordx4 v[168:171], v7, s[44:47], s83 offen offset:2048 sc1
    buffer_load_dwordx4 v[172:175], v7, s[44:47], s83 offen offset:3072 sc1
    v_mfma_f32_16x16x32_bf16 v[176:179], v[12:15], v[112:115], 0
    s_add_u32 s83, s78, 1
    s_cmp_ge_u32 s83, 12
    s_cselect_b32 s82, 12, 0
    s_sub_u32 s83, s83, s82
    s_add_u32 s83, s83, s79
    s_mul_i32 s98, s83, 5120
    s_add_u32 s98, s98, s80
    s_lshl_b32 s83, s83, 12
    s_add_u32 s83, s83, s81
    v_mfma_f32_16x16x32_bf16 v[192:195], v[16:19], v[112:115], 0
    v_mfma_f32_16x16x32_bf16 v[208:211], v[20:23], v[112:115], 0
    v_mfma_f32_16x16x32_bf16 v[224:227], v[24:27], v[112:115], 0
    v_mfma_f32_16x16x32_bf16 v[240:243], v[28:31], v[112:115], 0
    buffer_load_dwordx4 v[112:115], v7, s[44:47], s83 offen offset:0 sc1
    v_mfma_f32_16x16x32_bf16 v[180:183], v[12:15], v[116:119], 0
    v_mfma_f32_16x16x32_bf16 v[196:199], v[16:19], v[116:119], 0
    v_mfma_f32_16x16x32_bf16 v[212:215], v[20:23], v[116:119], 0
    v_mfma_f32_16x16x32_bf16 v[228:231], v[24:27], v[116:119], 0
    v_mfma_f32_16x16x32_bf16 v[244:247], v[28:31], v[116:119], 0
    buffer_load_dwordx4 v[116:119], v7, s[44:47], s83 offen offset:1024 sc1
    v_mfma_f32_16x16x32_bf16 v[184:187], v[12:15], v[120:123], 0
    v_mfma_f32_16x16x32_bf16 v[200:203], v[16:19], v[120:123], 0
    v_mfma_f32_16x16x32_bf16 v[216:219], v[20:23], v[120:123], 0
    v_mfma_f32_16x16x32_bf16 v[232:235], v[24:27], v[120:123], 0
    v_mfma_f32_16x16x32_bf16 v[248:251], v[28:31], v[120:123], 0
    buffer_load_dwordx4 v[120:123], v7, s[44:47], s83 offen offset:2048 sc1
    v_mfma_f32_16x16x32_bf16 v[188:191], v[12:15], v[124:127], 0
    v_mfma_f32_16x16x32_bf16 v[204:207], v[16:19], v[124:127], 0
    v_mfma_f32_16x16x32_bf16 v[220:223], v[20:23], v[124:127], 0
    v_mfma_f32_16x16x32_bf16 v[236:239], v[24:27], v[124:127], 0
    v_mfma_f32_16x16x32_bf16 v[252:255], v[28:31], v[124:127], 0
    buffer_load_dwordx4 v[124:127], v7, s[44:47], s83 offen offset:3072 sc1
    s_waitcnt vmcnt(12)
    v_mfma_f32_16x16x32_bf16 v[176:179], v[32:35], v[128:131], v[176:179]
    s_add_u32 s83, s78, 4
    s_cmp_ge_u32 s83, 12
    s_cselect_b32 s82, 12, 0
    s_sub_u32 s83, s83, s82
    s_add_u32 s83, s83, s79
    s_mul_i32 s98, s83, 5120
    s_add_u32 s98, s98, s80
    s_lshl_b32 s83, s83, 12
    s_add_u32 s83, s83, s81
    v_mfma_f32_16x16x32_bf16 v[192:195], v[36:39], v[128:131], v[192:195]
    v_mfma_f32_16x16x32_bf16 v[208:211], v[40:43], v[128:131], v[208:211]
    ds_read_b128 v[12:15], v10 offset:0
    v_mfma_f32_16x16x32_bf16 v[224:227], v[44:47], v[128:131], v[224:227]
    v_mfma_f32_16x16x32_bf16 v[240:243], v[48:51], v[128:131], v[240:243]
    buffer_load_dwordx4 v[128:131], v7, s[44:47], s83 offen offset:0 sc1
    v_mfma_f32_16x16x32_bf16 v[180:183], v[32:35], v[132:135], v[180:183]
    v_mfma_f32_16x16x32_bf16 v[196:199], v[36:39], v[132:135], v[196:199]
    ds_read_b128 v[16:19], v10 offset:1024
    v_mfma_f32_16x16x32_bf16 v[212:215], v[40:43], v[132:135], v[212:215]
    v_mfma_f32_16x16x32_bf16 v[228:231], v[44:47], v[132:135], v[228:231]
    v_mfma_f32_16x16x32_bf16 v[244:247], v[48:51], v[132:135], v[244:247]
    buffer_load_dwordx4 v[132:135], v7, s[44:47], s83 offen offset:1024 sc1
    v_mfma_f32_16x16x32_bf16 v[184:187], v[32:35], v[136:139], v[184:187]
    ds_read_b128 v[20:23], v10 offset:2048
    v_mfma_f32_16x16x32_bf16 v[200:203], v[36:39], v[136:139], v[200:203]
    v_mfma_f32_16x16x32_bf16 v[216:219], v[40:43], v[136:139], v[216:219]
    v_mfma_f32_16x16x32_bf16 v[232:235], v[44:47], v[136:139], v[232:235]
    v_mfma_f32_16x16x32_bf16 v[248:251], v[48:51], v[136:139], v[248:251]
    buffer_load_dwordx4 v[136:139], v7, s[44:47], s83 offen offset:2048 sc1
    ds_read_b128 v[24:27], v10 offset:3072
    v_mfma_f32_16x16x32_bf16 v[188:191], v[32:35], v[140:143], v[188:191]
    v_mfma_f32_16x16x32_bf16 v[204:207], v[36:39], v[140:143], v[204:207]
    v_mfma_f32_16x16x32_bf16 v[220:223], v[40:43], v[140:143], v[220:223]
    v_mfma_f32_16x16x32_bf16 v[236:239], v[44:47], v[140:143], v[236:239]
    ds_read_b128 v[28:31], v10 offset:4096
    v_mfma_f32_16x16x32_bf16 v[252:255], v[48:51], v[140:143], v[252:255]
    buffer_load_dwordx4 v[140:143], v7, s[44:47], s83 offen offset:3072 sc1
    s_waitcnt vmcnt(12)
    v_mfma_f32_16x16x32_bf16 v[176:179], v[52:55], v[144:147], v[176:179]
    s_add_u32 s83, s78, 7
    s_cmp_ge_u32 s83, 12
    s_cselect_b32 s82, 12, 0
    s_sub_u32 s83, s83, s82
    s_add_u32 s83, s83, s79
    s_mul_i32 s98, s83, 5120
    s_add_u32 s98, s98, s80
    s_lshl_b32 s83, s83, 12
    s_add_u32 s83, s83, s81
    v_mfma_f32_16x16x32_bf16 v[192:195], v[56:59], v[144:147], v[192:195]
    v_mfma_f32_16x16x32_bf16 v[208:211], v[60:63], v[144:147], v[208:211]
    ds_read_b128 v[32:35], v10 offset:5120
    v_mfma_f32_16x16x32_bf16 v[224:227], v[64:67], v[144:147], v[224:227]
    v_mfma_f32_16x16x32_bf16 v[240:243], v[68:71], v[144:147], v[240:243]
    buffer_load_dwordx4 v[144:147], v7, s[44:47], s83 offen offset:0 sc1
    v_mfma_f32_16x16x32_bf16 v[180:183], v[52:55], v[148:151], v[180:183]
    v_mfma_f32_16x16x32_bf16 v[196:199], v[56:59], v[148:151], v[196:199]
    ds_read_b128 v[36:39], v10 offset:6144
    v_mfma_f32_16x16x32_bf16 v[212:215], v[60:63], v[148:151], v[212:215]
    v_mfma_f32_16x16x32_bf16 v[228:231], v[64:67], v[148:151], v[228:231]
    v_mfma_f32_16x16x32_bf16 v[244:247], v[68:71], v[148:151], v[244:247]
    buffer_load_dwordx4 v[148:151], v7, s[44:47], s83 offen offset:1024 sc1
    v_mfma_f32_16x16x32_bf16 v[184:187], v[52:55], v[152:155], v[184:187]
    ds_read_b128 v[40:43], v10 offset:7168
    v_mfma_f32_16x16x32_bf16 v[200:203], v[56:59], v[152:155], v[200:203]
    v_mfma_f32_16x16x32_bf16 v[216:219], v[60:63], v[152:155], v[216:219]
    v_mfma_f32_16x16x32_bf16 v[232:235], v[64:67], v[152:155], v[232:235]
    v_mfma_f32_16x16x32_bf16 v[248:251], v[68:71], v[152:155], v[248:251]
    buffer_load_dwordx4 v[152:155], v7, s[44:47], s83 offen offset:2048 sc1
    ds_read_b128 v[44:47], v10 offset:8192
    v_mfma_f32_16x16x32_bf16 v[188:191], v[52:55], v[156:159], v[188:191]
    v_mfma_f32_16x16x32_bf16 v[204:207], v[56:59], v[156:159], v[204:207]
    v_mfma_f32_16x16x32_bf16 v[220:223], v[60:63], v[156:159], v[220:223]
    v_mfma_f32_16x16x32_bf16 v[236:239], v[64:67], v[156:159], v[236:239]
    ds_read_b128 v[48:51], v10 offset:9216
    v_mfma_f32_16x16x32_bf16 v[252:255], v[68:71], v[156:159], v[252:255]
    buffer_load_dwordx4 v[156:159], v7, s[44:47], s83 offen offset:3072 sc1
    s_waitcnt vmcnt(12)
    v_mfma_f32_16x16x32_bf16 v[176:179], v[72:75], v[160:163], v[176:179]
    s_add_u32 s83, s78, 10
    s_cmp_ge_u32 s83, 12
    s_cselect_b32 s82, 12, 0
    s_sub_u32 s83, s83, s82
    s_add_u32 s83, s83, s79
    s_mul_i32 s98, s83, 5120
    s_add_u32 s98, s98, s80
    s_lshl_b32 s83, s83, 12
    s_add_u32 s83, s83, s81
    v_mfma_f32_16x16x32_bf16 v[192:195], v[76:79], v[160:163], v[192:195]
    v_mfma_f32_16x16x32_bf16 v[208:211], v[80:83], v[160:163], v[208:211]
    ds_read_b128 v[52:55], v10 offset:10240
    v_mfma_f32_16x16x32_bf16 v[224:227], v[84:87], v[160:163], v[224:227]
    v_mfma_f32_16x16x32_bf16 v[240:243], v[88:91], v[160:163], v[240:243]
    buffer_load_dwordx4 v[160:163], v7, s[44:47], s83 offen offset:0 sc1
    v_mfma_f32_16x16x32_bf16 v[180:183], v[72:75], v[164:167], v[180:183]
    v_mfma_f32_16x16x32_bf16 v[196:199], v[76:79], v[164:167], v[196:199]
    ds_read_b128 v[56:59], v10 offset:11264
    v_mfma_f32_16x16x32_bf16 v[212:215], v[80:83], v[164:167], v[212:215]
    v_mfma_f32_16x16x32_bf16 v[228:231], v[84:87], v[164:167], v[228:231]
    v_mfma_f32_16x16x32_bf16 v[244:247], v[88:91], v[164:167], v[244:247]
    buffer_load_dwordx4 v[164:167], v7, s[44:47], s83 offen offset:1024 sc1
    v_mfma_f32_16x16x32_bf16 v[184:187], v[72:75], v[168:171], v[184:187]
    ds_read_b128 v[60:63], v10 offset:12288
    v_mfma_f32_16x16x32_bf16 v[200:203], v[76:79], v[168:171], v[200:203]
    v_mfma_f32_16x16x32_bf16 v[216:219], v[80:83], v[168:171], v[216:219]
    v_mfma_f32_16x16x32_bf16 v[232:235], v[84:87], v[168:171], v[232:235]
    v_mfma_f32_16x16x32_bf16 v[248:251], v[88:91], v[168:171], v[248:251]
    buffer_load_dwordx4 v[168:171], v7, s[44:47], s83 offen offset:2048 sc1
    ds_read_b128 v[64:67], v10 offset:13312
    v_mfma_f32_16x16x32_bf16 v[188:191], v[72:75], v[172:175], v[188:191]
    v_mfma_f32_16x16x32_bf16 v[204:207], v[76:79], v[172:175], v[204:207]
    v_mfma_f32_16x16x32_bf16 v[220:223], v[80:83], v[172:175], v[220:223]
    v_mfma_f32_16x16x32_bf16 v[236:239], v[84:87], v[172:175], v[236:239]
    ds_read_b128 v[68:71], v10 offset:14336
    v_mfma_f32_16x16x32_bf16 v[252:255], v[88:91], v[172:175], v[252:255]
    buffer_load_dwordx4 v[172:175], v7, s[44:47], s83 offen offset:3072 sc1
    s_waitcnt vmcnt(12)
    v_mfma_f32_16x16x32_bf16 v[176:179], v[92:95], v[112:115], v[176:179]
    s_add_u32 s83, s78, 2
    s_cmp_ge_u32 s83, 12
    s_cselect_b32 s82, 12, 0
    s_sub_u32 s83, s83, s82
    s_add_u32 s83, s83, s79
    s_mul_i32 s98, s83, 5120
    s_add_u32 s98, s98, s80
    s_lshl_b32 s83, s83, 12
    s_add_u32 s83, s83, s81
    v_mfma_f32_16x16x32_bf16 v[192:195], v[96:99], v[112:115], v[192:195]
    v_mfma_f32_16x16x32_bf16 v[208:211], v[100:103], v[112:115], v[208:211]
    ds_read_b128 v[72:75], v10 offset:15360
    v_mfma_f32_16x16x32_bf16 v[224:227], v[104:107], v[112:115], v[224:227]
    v_mfma_f32_16x16x32_bf16 v[240:243], v[108:111], v[112:115], v[240:243]
    buffer_load_dwordx4 v[112:115], v7, s[44:47], s83 offen offset:0 sc1
    v_mfma_f32_16x16x32_bf16 v[180:183], v[92:95], v[116:119], v[180:183]
    v_mfma_f32_16x16x32_bf16 v[196:199], v[96:99], v[116:119], v[196:199]
    ds_read_b128 v[76:79], v10 offset:16384
    v_mfma_f32_16x16x32_bf16 v[212:215], v[100:103], v[116:119], v[212:215]
    v_mfma_f32_16x16x32_bf16 v[228:231], v[104:107], v[116:119], v[228:231]
    v_mfma_f32_16x16x32_bf16 v[244:247], v[108:111], v[116:119], v[244:247]
    buffer_load_dwordx4 v[116:119], v7, s[44:47], s83 offen offset:1024 sc1
    v_mfma_f32_16x16x32_bf16 v[184:187], v[92:95], v[120:123], v[184:187]
    ds_read_b128 v[80:83], v10 offset:17408
    v_mfma_f32_16x16x32_bf16 v[200:203], v[96:99], v[120:123], v[200:203]
    v_mfma_f32_16x16x32_bf16 v[216:219], v[100:103], v[120:123], v[216:219]
    v_mfma_f32_16x16x32_bf16 v[232:235], v[104:107], v[120:123], v[232:235]
    v_mfma_f32_16x16x32_bf16 v[248:251], v[108:111], v[120:123], v[248:251]
    buffer_load_dwordx4 v[120:123], v7, s[44:47], s83 offen offset:2048 sc1
    ds_read_b128 v[84:87], v10 offset:18432
    v_mfma_f32_16x16x32_bf16 v[188:191], v[92:95], v[124:127], v[188:191]
    v_mfma_f32_16x16x32_bf16 v[204:207], v[96:99], v[124:127], v[204:207]
    v_mfma_f32_16x16x32_bf16 v[220:223], v[100:103], v[124:127], v[220:223]
    v_mfma_f32_16x16x32_bf16 v[236:239], v[104:107], v[124:127], v[236:239]
    ds_read_b128 v[88:91], v10 offset:19456
    v_mfma_f32_16x16x32_bf16 v[252:255], v[108:111], v[124:127], v[252:255]
    buffer_load_dwordx4 v[124:127], v7, s[44:47], s83 offen offset:3072 sc1
    s_waitcnt vmcnt(12)
    s_waitcnt lgkmcnt(0)
    v_mfma_f32_16x16x32_bf16 v[176:179], v[12:15], v[128:131], v[176:179]
    s_add_u32 s83, s78, 5
    s_cmp_ge_u32 s83, 12
    s_cselect_b32 s82, 12, 0
    s_sub_u32 s83, s83, s82
    s_add_u32 s83, s83, s79
    s_mul_i32 s98, s83, 5120
    s_add_u32 s98, s98, s80
    s_lshl_b32 s83, s83, 12
    s_add_u32 s83, s83, s81
    v_mfma_f32_16x16x32_bf16 v[192:195], v[16:19], v[128:131], v[192:195]
    v_mfma_f32_16x16x32_bf16 v[208:211], v[20:23], v[128:131], v[208:211]
    buffer_load_dwordx4 v[92:95], v7, s[44:47], s98 offen offset:0 sc1
    v_mfma_f32_16x16x32_bf16 v[224:227], v[24:27], v[128:131], v[224:227]
    v_mfma_f32_16x16x32_bf16 v[240:243], v[28:31], v[128:131], v[240:243]
    buffer_load_dwordx4 v[128:131], v7, s[44:47], s83 offen offset:0 sc1
    v_mfma_f32_16x16x32_bf16 v[180:183], v[12:15], v[132:135], v[180:183]
    v_mfma_f32_16x16x32_bf16 v[196:199], v[16:19], v[132:135], v[196:199]
    buffer_load_dwordx4 v[96:99], v7, s[44:47], s98 offen offset:1024 sc1
    v_mfma_f32_16x16x32_bf16 v[212:215], v[20:23], v[132:135], v[212:215]
    v_mfma_f32_16x16x32_bf16 v[228:231], v[24:27], v[132:135], v[228:231]
    v_mfma_f32_16x16x32_bf16 v[244:247], v[28:31], v[132:135], v[244:247]
    buffer_load_dwordx4 v[132:135], v7, s[44:47], s83 offen offset:1024 sc1
    v_mfma_f32_16x16x32_bf16 v[184:187], v[12:15], v[136:139], v[184:187]
    buffer_load_dwordx4 v[100:103], v7, s[44:47], s98 offen offset:2048 sc1
    v_mfma_f32_16x16x32_bf16 v[200:203], v[16:19], v[136:139], v[200:203]
    v_mfma_f32_16x16x32_bf16 v[216:219], v[20:23], v[136:139], v[216:219]
    v_mfma_f32_16x16x32_bf16 v[232:235], v[24:27], v[136:139], v[232:235]
    v_mfma_f32_16x16x32_bf16 v[248:251], v[28:31], v[136:139], v[248:251]
    buffer_load_dwordx4 v[136:139], v7, s[44:47], s83 offen offset:2048 sc1
    buffer_load_dwordx4 v[104:107], v7, s[44:47], s98 offen offset:3072 sc1
    v_mfma_f32_16x16x32_bf16 v[188:191], v[12:15], v[140:143], v[188:191]
    v_mfma_f32_16x16x32_bf16 v[204:207], v[16:19], v[140:143], v[204:207]
    v_mfma_f32_16x16x32_bf16 v[220:223], v[20:23], v[140:143], v[220:223]
    v_mfma_f32_16x16x32_bf16 v[236:239], v[24:27], v[140:143], v[236:239]
    buffer_load_dwordx4 v[108:111], v8, s[44:47], s98 offen sc1
    v_mfma_f32_16x16x32_bf16 v[252:255], v[28:31], v[140:143], v[252:255]
    buffer_load_dwordx4 v[140:143], v7, s[44:47], s83 offen offset:3072 sc1
    s_waitcnt vmcnt(17)
    s_waitcnt lgkmcnt(0)
    v_mfma_f32_16x16x32_bf16 v[176:179], v[32:35], v[144:147], v[176:179]
    s_add_u32 s83, s78, 8
    s_cmp_ge_u32 s83, 12
    s_cselect_b32 s82, 12, 0
    s_sub_u32 s83, s83, s82
    s_add_u32 s83, s83, s79
    s_mul_i32 s98, s83, 5120
    s_add_u32 s98, s98, s80
    s_lshl_b32 s83, s83, 12
    s_add_u32 s83, s83, s81
    v_mfma_f32_16x16x32_bf16 v[192:195], v[36:39], v[144:147], v[192:195]
    v_mfma_f32_16x16x32_bf16 v[208:211], v[40:43], v[144:147], v[208:211]
    buffer_load_dwordx4 v[12:15], v7, s[44:47], s98 offen offset:0 sc1
    v_mfma_f32_16x16x32_bf16 v[224:227], v[44:47], v[144:147], v[224:227]
    v_mfma_f32_16x16x32_bf16 v[240:243], v[48:51], v[144:147], v[240:243]
    buffer_load_dwordx4 v[144:147], v7, s[44:47], s83 offen offset:0 sc1
    v_mfma_f32_16x16x32_bf16 v[180:183], v[32:35], v[148:151], v[180:183]
    v_mfma_f32_16x16x32_bf16 v[196:199], v[36:39], v[148:151], v[196:199]
    buffer_load_dwordx4 v[16:19], v7, s[44:47], s98 offen offset:1024 sc1
    v_mfma_f32_16x16x32_bf16 v[212:215], v[40:43], v[148:151], v[212:215]
    v_mfma_f32_16x16x32_bf16 v[228:231], v[44:47], v[148:151], v[228:231]
    v_mfma_f32_16x16x32_bf16 v[244:247], v[48:51], v[148:151], v[244:247]
    buffer_load_dwordx4 v[148:151], v7, s[44:47], s83 offen offset:1024 sc1
    v_mfma_f32_16x16x32_bf16 v[184:187], v[32:35], v[152:155], v[184:187]
    buffer_load_dwordx4 v[20:23], v7, s[44:47], s98 offen offset:2048 sc1
    v_mfma_f32_16x16x32_bf16 v[200:203], v[36:39], v[152:155], v[200:203]
    v_mfma_f32_16x16x32_bf16 v[216:219], v[40:43], v[152:155], v[216:219]
    v_mfma_f32_16x16x32_bf16 v[232:235], v[44:47], v[152:155], v[232:235]
    v_mfma_f32_16x16x32_bf16 v[248:251], v[48:51], v[152:155], v[248:251]
    buffer_load_dwordx4 v[152:155], v7, s[44:47], s83 offen offset:2048 sc1
    buffer_load_dwordx4 v[24:27], v7, s[44:47], s98 offen offset:3072 sc1
    v_mfma_f32_16x16x32_bf16 v[188:191], v[32:35], v[156:159], v[188:191]
    v_mfma_f32_16x16x32_bf16 v[204:207], v[36:39], v[156:159], v[204:207]
    v_mfma_f32_16x16x32_bf16 v[220:223], v[40:43], v[156:159], v[220:223]
    v_mfma_f32_16x16x32_bf16 v[236:239], v[44:47], v[156:159], v[236:239]
    buffer_load_dwordx4 v[28:31], v8, s[44:47], s98 offen sc1
    v_mfma_f32_16x16x32_bf16 v[252:255], v[48:51], v[156:159], v[252:255]
    buffer_load_dwordx4 v[156:159], v7, s[44:47], s83 offen offset:3072 sc1
    v_mov_b32 v2, 163128
    v_mov_b32 v3, 2
    ds_write_b32 v2, v3
    s_waitcnt vmcnt(22)
    s_waitcnt lgkmcnt(0)
    v_mfma_f32_16x16x32_bf16 v[176:179], v[52:55], v[160:163], v[176:179]
    s_add_u32 s83, s78, 11
    s_cmp_ge_u32 s83, 12
    s_cselect_b32 s82, 12, 0
    s_sub_u32 s83, s83, s82
    s_add_u32 s83, s83, s79
    s_mul_i32 s98, s83, 5120
    s_add_u32 s98, s98, s80
    s_lshl_b32 s83, s83, 12
    s_add_u32 s83, s83, s81
    v_mfma_f32_16x16x32_bf16 v[192:195], v[56:59], v[160:163], v[192:195]
    v_mfma_f32_16x16x32_bf16 v[208:211], v[60:63], v[160:163], v[208:211]
    buffer_load_dwordx4 v[32:35], v7, s[44:47], s98 offen offset:0 sc1
    v_mfma_f32_16x16x32_bf16 v[224:227], v[64:67], v[160:163], v[224:227]
    v_mfma_f32_16x16x32_bf16 v[240:243], v[68:71], v[160:163], v[240:243]
    buffer_load_dwordx4 v[160:163], v7, s[44:47], s83 offen offset:0 sc1
    v_mfma_f32_16x16x32_bf16 v[180:183], v[52:55], v[164:167], v[180:183]
    v_mfma_f32_16x16x32_bf16 v[196:199], v[56:59], v[164:167], v[196:199]
    buffer_load_dwordx4 v[36:39], v7, s[44:47], s98 offen offset:1024 sc1
    v_mfma_f32_16x16x32_bf16 v[212:215], v[60:63], v[164:167], v[212:215]
    v_mfma_f32_16x16x32_bf16 v[228:231], v[64:67], v[164:167], v[228:231]
    v_mfma_f32_16x16x32_bf16 v[244:247], v[68:71], v[164:167], v[244:247]
    buffer_load_dwordx4 v[164:167], v7, s[44:47], s83 offen offset:1024 sc1
    v_mfma_f32_16x16x32_bf16 v[184:187], v[52:55], v[168:171], v[184:187]
    buffer_load_dwordx4 v[40:43], v7, s[44:47], s98 offen offset:2048 sc1
    v_mfma_f32_16x16x32_bf16 v[200:203], v[56:59], v[168:171], v[200:203]
    v_mfma_f32_16x16x32_bf16 v[216:219], v[60:63], v[168:171], v[216:219]
    v_mfma_f32_16x16x32_bf16 v[232:235], v[64:67], v[168:171], v[232:235]
    v_mfma_f32_16x16x32_bf16 v[248:251], v[68:71], v[168:171], v[248:251]
    buffer_load_dwordx4 v[168:171], v7, s[44:47], s83 offen offset:2048 sc1
    buffer_load_dwordx4 v[44:47], v7, s[44:47], s98 offen offset:3072 sc1
    v_mfma_f32_16x16x32_bf16 v[188:191], v[52:55], v[172:175], v[188:191]
    v_mfma_f32_16x16x32_bf16 v[204:207], v[56:59], v[172:175], v[204:207]
    v_mfma_f32_16x16x32_bf16 v[220:223], v[60:63], v[172:175], v[220:223]
    v_mfma_f32_16x16x32_bf16 v[236:239], v[64:67], v[172:175], v[236:239]
    buffer_load_dwordx4 v[48:51], v8, s[44:47], s98 offen sc1
    v_mfma_f32_16x16x32_bf16 v[252:255], v[68:71], v[172:175], v[252:255]
    buffer_load_dwordx4 v[172:175], v7, s[44:47], s83 offen offset:3072 sc1
    s_waitcnt vmcnt(27)
    s_waitcnt lgkmcnt(0)
    v_mfma_f32_16x16x32_bf16 v[176:179], v[72:75], v[112:115], v[176:179]
    v_mfma_f32_16x16x32_bf16 v[192:195], v[76:79], v[112:115], v[192:195]
    v_mfma_f32_16x16x32_bf16 v[208:211], v[80:83], v[112:115], v[208:211]
    v_mfma_f32_16x16x32_bf16 v[224:227], v[84:87], v[112:115], v[224:227]
    v_mfma_f32_16x16x32_bf16 v[240:243], v[88:91], v[112:115], v[240:243]
    v_mfma_f32_16x16x32_bf16 v[180:183], v[72:75], v[116:119], v[180:183]
    v_mfma_f32_16x16x32_bf16 v[196:199], v[76:79], v[116:119], v[196:199]
    v_mfma_f32_16x16x32_bf16 v[212:215], v[80:83], v[116:119], v[212:215]
    v_mfma_f32_16x16x32_bf16 v[228:231], v[84:87], v[116:119], v[228:231]
    v_mfma_f32_16x16x32_bf16 v[244:247], v[88:91], v[116:119], v[244:247]
    v_mfma_f32_16x16x32_bf16 v[184:187], v[72:75], v[120:123], v[184:187]
    v_mfma_f32_16x16x32_bf16 v[200:203], v[76:79], v[120:123], v[200:203]
    v_mfma_f32_16x16x32_bf16 v[216:219], v[80:83], v[120:123], v[216:219]
    v_mfma_f32_16x16x32_bf16 v[232:235], v[84:87], v[120:123], v[232:235]
    v_mfma_f32_16x16x32_bf16 v[248:251], v[88:91], v[120:123], v[248:251]
    v_mfma_f32_16x16x32_bf16 v[188:191], v[72:75], v[124:127], v[188:191]
    v_mfma_f32_16x16x32_bf16 v[204:207], v[76:79], v[124:127], v[204:207]
    v_mfma_f32_16x16x32_bf16 v[220:223], v[80:83], v[124:127], v[220:223]
    v_mfma_f32_16x16x32_bf16 v[236:239], v[84:87], v[124:127], v[236:239]
    v_mfma_f32_16x16x32_bf16 v[252:255], v[88:91], v[124:127], v[252:255]
    s_waitcnt vmcnt(18)
    v_mfma_f32_16x16x32_bf16 v[176:179], v[92:95], v[128:131], v[176:179]
    v_mfma_f32_16x16x32_bf16 v[192:195], v[96:99], v[128:131], v[192:195]
    v_mfma_f32_16x16x32_bf16 v[208:211], v[100:103], v[128:131], v[208:211]
    v_mfma_f32_16x16x32_bf16 v[224:227], v[104:107], v[128:131], v[224:227]
    v_mfma_f32_16x16x32_bf16 v[240:243], v[108:111], v[128:131], v[240:243]
    v_mfma_f32_16x16x32_bf16 v[180:183], v[92:95], v[132:135], v[180:183]
    v_mfma_f32_16x16x32_bf16 v[196:199], v[96:99], v[132:135], v[196:199]
    v_mfma_f32_16x16x32_bf16 v[212:215], v[100:103], v[132:135], v[212:215]
    v_mfma_f32_16x16x32_bf16 v[228:231], v[104:107], v[132:135], v[228:231]
    v_mfma_f32_16x16x32_bf16 v[244:247], v[108:111], v[132:135], v[244:247]
    v_mfma_f32_16x16x32_bf16 v[184:187], v[92:95], v[136:139], v[184:187]
    v_mfma_f32_16x16x32_bf16 v[200:203], v[96:99], v[136:139], v[200:203]
    v_mfma_f32_16x16x32_bf16 v[216:219], v[100:103], v[136:139], v[216:219]
    v_mfma_f32_16x16x32_bf16 v[232:235], v[104:107], v[136:139], v[232:235]
    v_mfma_f32_16x16x32_bf16 v[248:251], v[108:111], v[136:139], v[248:251]
    v_mfma_f32_16x16x32_bf16 v[188:191], v[92:95], v[140:143], v[188:191]
    v_mfma_f32_16x16x32_bf16 v[204:207], v[96:99], v[140:143], v[204:207]
    v_mfma_f32_16x16x32_bf16 v[220:223], v[100:103], v[140:143], v[220:223]
    v_mfma_f32_16x16x32_bf16 v[236:239], v[104:107], v[140:143], v[236:239]
    v_mfma_f32_16x16x32_bf16 v[252:255], v[108:111], v[140:143], v[252:255]
    s_waitcnt vmcnt(9)
    v_mfma_f32_16x16x32_bf16 v[176:179], v[12:15], v[144:147], v[176:179]
    v_mfma_f32_16x16x32_bf16 v[192:195], v[16:19], v[144:147], v[192:195]
    v_mfma_f32_16x16x32_bf16 v[208:211], v[20:23], v[144:147], v[208:211]
    v_mfma_f32_16x16x32_bf16 v[224:227], v[24:27], v[144:147], v[224:227]
    v_mfma_f32_16x16x32_bf16 v[240:243], v[28:31], v[144:147], v[240:243]
    v_mfma_f32_16x16x32_bf16 v[180:183], v[12:15], v[148:151], v[180:183]
    v_mfma_f32_16x16x32_bf16 v[196:199], v[16:19], v[148:151], v[196:199]
    v_mfma_f32_16x16x32_bf16 v[212:215], v[20:23], v[148:151], v[212:215]
    v_mfma_f32_16x16x32_bf16 v[228:231], v[24:27], v[148:151], v[228:231]
    v_mfma_f32_16x16x32_bf16 v[244:247], v[28:31], v[148:151], v[244:247]
    v_mfma_f32_16x16x32_bf16 v[184:187], v[12:15], v[152:155], v[184:187]
    v_mfma_f32_16x16x32_bf16 v[200:203], v[16:19], v[152:155], v[200:203]
    v_mfma_f32_16x16x32_bf16 v[216:219], v[20:23], v[152:155], v[216:219]
    v_mfma_f32_16x16x32_bf16 v[232:235], v[24:27], v[152:155], v[232:235]
    v_mfma_f32_16x16x32_bf16 v[248:251], v[28:31], v[152:155], v[248:251]
    v_mfma_f32_16x16x32_bf16 v[188:191], v[12:15], v[156:159], v[188:191]
    v_mfma_f32_16x16x32_bf16 v[204:207], v[16:19], v[156:159], v[204:207]
    v_mfma_f32_16x16x32_bf16 v[220:223], v[20:23], v[156:159], v[220:223]
    v_mfma_f32_16x16x32_bf16 v[236:239], v[24:27], v[156:159], v[236:239]
    v_mfma_f32_16x16x32_bf16 v[252:255], v[28:31], v[156:159], v[252:255]
    s_waitcnt vmcnt(0)
    v_mfma_f32_16x16x32_bf16 v[176:179], v[32:35], v[160:163], v[176:179]
    v_and_b32 v12, 15, v1
    v_lshrrev_b32 v13, 4, v1
    v_bfe_u32 v14, v1, 1, 2
    v_xor_b32 v13, v13, v14
    v_mfma_f32_16x16x32_bf16 v[192:195], v[36:39], v[160:163], v[192:195]
    v_mul_u32_u24 v12, 320, v12
    v_lshl_add_u32 v12, v13, 4, v12
    v_add_u32 v12, s92, v12
    v_mfma_f32_16x16x32_bf16 v[208:211], v[40:43], v[160:163], v[208:211]
    v_mfma_f32_16x16x32_bf16 v[224:227], v[44:47], v[160:163], v[224:227]
    v_mfma_f32_16x16x32_bf16 v[240:243], v[48:51], v[160:163], v[240:243]
    v_mfma_f32_16x16x32_bf16 v[180:183], v[32:35], v[164:167], v[180:183]
    v_mfma_f32_16x16x32_bf16 v[196:199], v[36:39], v[164:167], v[196:199]
    v_mfma_f32_16x16x32_bf16 v[212:215], v[40:43], v[164:167], v[212:215]
    v_mfma_f32_16x16x32_bf16 v[228:231], v[44:47], v[164:167], v[228:231]
    ds_write_b128 v12, v[176:179] offset:0
    v_mfma_f32_16x16x32_bf16 v[244:247], v[48:51], v[164:167], v[244:247]
    ds_write_b128 v12, v[192:195] offset:64
    v_mfma_f32_16x16x32_bf16 v[184:187], v[32:35], v[168:171], v[184:187]
    ds_write_b128 v12, v[208:211] offset:128
    v_mfma_f32_16x16x32_bf16 v[200:203], v[36:39], v[168:171], v[200:203]
    ds_write_b128 v12, v[224:227] offset:192
    v_mfma_f32_16x16x32_bf16 v[216:219], v[40:43], v[168:171], v[216:219]
    ds_write_b128 v12, v[240:243] offset:256
    v_mfma_f32_16x16x32_bf16 v[232:235], v[44:47], v[168:171], v[232:235]
    ds_write_b128 v12, v[180:183] offset:5120
    v_mfma_f32_16x16x32_bf16 v[248:251], v[48:51], v[168:171], v[248:251]
    ds_write_b128 v12, v[196:199] offset:5184
    v_mfma_f32_16x16x32_bf16 v[188:191], v[32:35], v[172:175], v[188:191]
    ds_write_b128 v12, v[212:215] offset:5248
    v_mfma_f32_16x16x32_bf16 v[204:207], v[36:39], v[172:175], v[204:207]
    ds_write_b128 v12, v[228:231] offset:5312
    v_mfma_f32_16x16x32_bf16 v[220:223], v[40:43], v[172:175], v[220:223]
    ds_write_b128 v12, v[244:247] offset:5376
    v_mfma_f32_16x16x32_bf16 v[236:239], v[44:47], v[172:175], v[236:239]
    ds_write_b128 v12, v[184:187] offset:10240
    v_mfma_f32_16x16x32_bf16 v[252:255], v[48:51], v[172:175], v[252:255]
    ds_write_b128 v12, v[200:203] offset:10304
    ds_write_b128 v12, v[216:219] offset:10368
    ds_write_b128 v12, v[232:235] offset:10432
    ds_write_b128 v12, v[248:251] offset:10496
    ds_write_b128 v12, v[188:191] offset:15360
    ds_write_b128 v12, v[204:207] offset:15424
    ds_write_b128 v12, v[220:223] offset:15488
    ds_write_b128 v12, v[236:239] offset:15552
    s_nop 0
    ds_write_b128 v12, v[252:255] offset:15616
L_final:
    s_setprio 0
    s_mov_b32 s48, s38
    s_and_b32 s49, s39, 0xffff
    s_mov_b32 s50, 2621440
    s_mov_b32 s51, 0x20000
    s_mul_i32 s74, s9, 81920
    s_mul_i32 s75, s10, 160
    s_add_u32 s74, s74, s75
    v_mul_u32_u24 v13, 6554, v0
    v_lshrrev_b32 v13, 16, v13
    v_mul_u32_u24 v14, 10, v13
    v_sub_u32 v14, v0, v14
    v_bfe_u32 v15, v13, 1, 2
    v_lshlrev_b32 v16, 1, v14
    v_xor_b32 v16, v16, v15
    v_xor_b32 v17, 1, v16
    v_mul_u32_u24 v15, 320, v13
    v_lshl_add_u32 v16, v16, 4, v15
    v_lshl_add_u32 v17, v17, 4, v15
    v_lshlrev_b32 v18, 4, v0
    v_add_u32 v18, 152832, v18
    v_lshlrev_b32 v19, 2, v13
    v_add_u32 v19, 163328, v19
    v_mul_u32_u24 v20, 1120, v13
    v_lshl_add_u32 v20, v0, 4, v20
    s_lshl_b32 s75, s3, 4
    s_add_u32 s75, s75, 512
    v_and_b32 v12, 15, v1
    v_add_u32 v12, s75, v12
    v_mul_u32_u24 v13, 6554, v12
    v_lshrrev_b32 v13, 16, v13
    v_mul_u32_u24 v14, 10, v13
    v_sub_u32 v14, v12, v14
    v_bfe_u32 v15, v13, 1, 2
    v_lshlrev_b32 v24, 1, v14
    v_xor_b32 v24, v24, v15
    v_xor_b32 v25, 1, v24
    v_mul_u32_u24 v15, 320, v13
    v_lshl_add_u32 v24, v24, 4, v15
    v_lshl_add_u32 v25, v25, 4, v15
    v_lshlrev_b32 v26, 4, v12
    v_add_u32 v26, 152832, v26
    v_lshlrev_b32 v27, 2, v13
    v_add_u32 v27, 163328, v27
    v_mul_u32_u24 v28, 1120, v13
    v_lshl_add_u32 v28, v12, 4, v28
    s_waitcnt lgkmcnt(0)
    s_barrier
    ds_read_b128 v[32:35], v16 offset:0
    ds_read_b128 v[36:39], v17 offset:0
    ds_read_b128 v[40:43], v16 offset:20480
    ds_read_b128 v[44:47], v17 offset:20480
    ds_read_b128 v[48:51], v16 offset:40960
    ds_read_b128 v[52:55], v17 offset:40960
    ds_read_b128 v[56:59], v16 offset:61440
    ds_read_b128 v[60:63], v17 offset:61440
    ds_read_b128 v[64:67], v18
    ds_read_b32 v68, v19
    s_mov_b64 exec, 0xffff
    ds_read_b128 v[72:75], v24 offset:0
    ds_read_b128 v[76:79], v25 offset:0
    ds_read_b128 v[80:83], v24 offset:20480
    ds_read_b128 v[84:87], v25 offset:20480
    ds_read_b128 v[88:91], v24 offset:40960
    ds_read_b128 v[92:95], v25 offset:40960
    ds_read_b128 v[96:99], v24 offset:61440
    ds_read_b128 v[100:103], v25 offset:61440
    ds_read_b128 v[104:107], v26
    ds_read_b32 v108, v27
    s_mov_b64 exec, -1
    s_waitcnt lgkmcnt(10)
    v_pk_add_f32 v[32:33], v[32:33], v[40:41]
    v_pk_add_f32 v[48:49], v[48:49], v[56:57]
    v_pk_add_f32 v[34:35], v[34:35], v[42:43]
    v_pk_add_f32 v[50:51], v[50:51], v[58:59]
    v_pk_add_f32 v[36:37], v[36:37], v[44:45]
    v_pk_add_f32 v[52:53], v[52:53], v[60:61]
    v_pk_add_f32 v[38:39], v[38:39], v[46:47]
    v_pk_add_f32 v[54:55], v[54:55], v[62:63]
    v_sub_f32 v68, 1.0, v68
    v_cvt_pk_bf16_f32 v68, v68, v68
    v_and_b32 v68, 0xffff0000, v68
    v_pk_add_f32 v[32:33], v[32:33], v[48:49]
    v_pk_add_f32 v[34:35], v[34:35], v[50:51]
    v_pk_add_f32 v[36:37], v[36:37], v[52:53]
    v_pk_add_f32 v[38:39], v[38:39], v[54:55]
    v_lshlrev_b32 v40, 16, v64
    v_and_b32 v41, 0xffff0000, v64
    v_pk_fma_f32 v[40:41], v[32:33], v[68:69], v[40:41] op_sel_hi:[1,0,1]
    v_lshlrev_b32 v42, 16, v65
    v_and_b32 v43, 0xffff0000, v65
    v_pk_fma_f32 v[42:43], v[34:35], v[68:69], v[42:43] op_sel_hi:[1,0,1]
    v_lshlrev_b32 v44, 16, v66
    v_and_b32 v45, 0xffff0000, v66
    v_pk_fma_f32 v[44:45], v[36:37], v[68:69], v[44:45] op_sel_hi:[1,0,1]
    v_lshlrev_b32 v46, 16, v67
    v_and_b32 v47, 0xffff0000, v67
    v_pk_fma_f32 v[46:47], v[38:39], v[68:69], v[46:47] op_sel_hi:[1,0,1]
    v_cvt_pk_bf16_f32 v64, v40, v41
    v_cvt_pk_bf16_f32 v65, v42, v43
    v_cvt_pk_bf16_f32 v66, v44, v45
    v_cvt_pk_bf16_f32 v67, v46, v47
    buffer_store_dwordx4 v[64:67], v20, s[48:51], s74 offen
    s_waitcnt lgkmcnt(0)
    s_mov_b64 exec, 0xffff
    v_pk_add_f32 v[72:73], v[72:73], v[80:81]
    v_pk_add_f32 v[88:89], v[88:89], v[96:97]
    v_pk_add_f32 v[74:75], v[74:75], v[82:83]
    v_pk_add_f32 v[90:91], v[90:91], v[98:99]
    v_pk_add_f32 v[76:77], v[76:77], v[84:85]
    v_pk_add_f32 v[92:93], v[92:93], v[100:101]
    v_pk_add_f32 v[78:79], v[78:79], v[86:87]
    v_pk_add_f32 v[94:95], v[94:95], v[102:103]
    v_sub_f32 v108, 1.0, v108
    v_cvt_pk_bf16_f32 v108, v108, v108
    v_and_b32 v108, 0xffff0000, v108
    v_pk_add_f32 v[72:73], v[72:73], v[88:89]
    v_pk_add_f32 v[74:75], v[74:75], v[90:91]
    v_pk_add_f32 v[76:77], v[76:77], v[92:93]
    v_pk_add_f32 v[78:79], v[78:79], v[94:95]
    v_lshlrev_b32 v80, 16, v104
    v_and_b32 v81, 0xffff0000, v104
    v_pk_fma_f32 v[80:81], v[72:73], v[108:109], v[80:81] op_sel_hi:[1,0,1]
    v_lshlrev_b32 v82, 16, v105
    v_and_b32 v83, 0xffff0000, v105
    v_pk_fma_f32 v[82:83], v[74:75], v[108:109], v[82:83] op_sel_hi:[1,0,1]
    v_lshlrev_b32 v84, 16, v106
    v_and_b32 v85, 0xffff0000, v106
    v_pk_fma_f32 v[84:85], v[76:77], v[108:109], v[84:85] op_sel_hi:[1,0,1]
    v_lshlrev_b32 v86, 16, v107
    v_and_b32 v87, 0xffff0000, v107
    v_pk_fma_f32 v[86:87], v[78:79], v[108:109], v[86:87] op_sel_hi:[1,0,1]
    v_cvt_pk_bf16_f32 v104, v80, v81
    v_cvt_pk_bf16_f32 v105, v82, v83
    v_cvt_pk_bf16_f32 v106, v84, v85
    v_cvt_pk_bf16_f32 v107, v86, v87
    buffer_store_dwordx4 v[104:107], v28, s[48:51], s74 offen
    s_mov_b64 exec, -1
L_fin2:
L_end:
    s_endpgm
L_kv:
    s_barrier
    ds_read_b128 v[42:45], v95 offset:13440
    ds_read_b128 v[46:49], v95 offset:13456
    ds_read_b64 v[12:13], v10 offset:0
    ds_read_b64 v[14:15], v10 offset:192
    ds_read_b64 v[16:17], v10 offset:384
    ds_read_b64 v[18:19], v10 offset:576
    ds_read_b64 v[20:21], v10 offset:768
    ds_read_b64 v[22:23], v10 offset:960
    ds_read_b64 v[24:25], v10 offset:1152
    ds_read_b64 v[26:27], v10 offset:1344
    ds_read_b64 v[28:29], v10 offset:1536
    s_waitcnt lgkmcnt(9)
    ds_read_b64 v[30:31], v10 offset:6720
    ds_read_b64 v[32:33], v10 offset:6912
    ds_read_b64 v[34:35], v10 offset:7104
    ds_read_b64 v[36:37], v10 offset:7296
    ds_read_b64 v[38:39], v10 offset:7488
    ds_read_b64 v[40:41], v10 offset:7680
    v_lshlrev_b32 v96, 16, v42
    v_and_b32 v100, 0xffff0000, v42
    v_lshlrev_b32 v104, 16, v43
    v_and_b32 v108, 0xffff0000, v43
    v_lshlrev_b32 v97, 16, v44
    v_and_b32 v101, 0xffff0000, v44
    v_lshlrev_b32 v105, 16, v45
    v_and_b32 v109, 0xffff0000, v45
    v_lshlrev_b32 v98, 16, v46
    v_and_b32 v102, 0xffff0000, v46
    v_lshlrev_b32 v106, 16, v47
    v_and_b32 v110, 0xffff0000, v47
    v_lshlrev_b32 v99, 16, v48
    v_and_b32 v103, 0xffff0000, v48
    v_lshlrev_b32 v107, 16, v49
    v_and_b32 v111, 0xffff0000, v49
    s_waitcnt lgkmcnt(0)
    s_mov_b32 exec_lo, -1
    s_mov_b32 exec_hi, 0xfffffff
    v_lshlrev_b32 v112, 16, v12
    v_and_b32 v113, 0xffff0000, v12
    v_lshlrev_b32 v114, 16, v14
    v_and_b32 v115, 0xffff0000, v14
    v_lshlrev_b32 v116, 16, v16
    v_and_b32 v117, 0xffff0000, v16
    v_lshlrev_b32 v118, 16, v18
    v_and_b32 v119, 0xffff0000, v18
    v_lshlrev_b32 v120, 16, v20
    v_and_b32 v121, 0xffff0000, v20
    v_lshlrev_b32 v122, 16, v22
    v_and_b32 v123, 0xffff0000, v22
    v_lshlrev_b32 v124, 16, v24
    v_and_b32 v125, 0xffff0000, v24
    v_lshlrev_b32 v126, 16, v26
    v_and_b32 v127, 0xffff0000, v26
    v_lshlrev_b32 v128, 16, v28
    v_and_b32 v129, 0xffff0000, v28
    v_lshlrev_b32 v130, 16, v30
    v_and_b32 v131, 0xffff0000, v30
    v_lshlrev_b32 v132, 16, v32
    v_and_b32 v133, 0xffff0000, v32
    v_lshlrev_b32 v134, 16, v34
    v_and_b32 v135, 0xffff0000, v34
    v_lshlrev_b32 v136, 16, v36
    v_and_b32 v137, 0xffff0000, v36
    v_lshlrev_b32 v138, 16, v38
    v_and_b32 v139, 0xffff0000, v38
    v_lshlrev_b32 v140, 16, v40
    v_and_b32 v141, 0xffff0000, v40
    v_pk_mul_f32 v[142:143], v[112:113], v[108:109]
    v_pk_mul_f32 v[144:145], v[114:115], v[108:109]
    v_pk_mul_f32 v[146:147], v[116:117], v[108:109]
    v_pk_mul_f32 v[148:149], v[118:119], v[108:109]
    v_pk_mul_f32 v[150:151], v[120:121], v[108:109]
    v_pk_mul_f32 v[152:153], v[122:123], v[108:109]
    v_pk_fma_f32 v[142:143], v[114:115], v[104:105], v[142:143]
    v_pk_fma_f32 v[144:145], v[116:117], v[104:105], v[144:145]
    v_pk_fma_f32 v[146:147], v[118:119], v[104:105], v[146:147]
    v_pk_fma_f32 v[148:149], v[120:121], v[104:105], v[148:149]
    v_pk_fma_f32 v[150:151], v[122:123], v[104:105], v[150:151]
    v_pk_fma_f32 v[152:153], v[124:125], v[104:105], v[152:153]
    v_pk_fma_f32 v[142:143], v[116:117], v[100:101], v[142:143]
    v_pk_fma_f32 v[144:145], v[118:119], v[100:101], v[144:145]
    v_pk_fma_f32 v[146:147], v[120:121], v[100:101], v[146:147]
    v_pk_fma_f32 v[148:149], v[122:123], v[100:101], v[148:149]
    v_pk_fma_f32 v[150:151], v[124:125], v[100:101], v[150:151]
    v_pk_fma_f32 v[152:153], v[126:127], v[100:101], v[152:153]
    v_pk_fma_f32 v[142:143], v[118:119], v[96:97], v[142:143]
    v_pk_fma_f32 v[144:145], v[120:121], v[96:97], v[144:145]
    v_pk_fma_f32 v[146:147], v[122:123], v[96:97], v[146:147]
    v_pk_fma_f32 v[148:149], v[124:125], v[96:97], v[148:149]
    v_pk_fma_f32 v[150:151], v[126:127], v[96:97], v[150:151]
    v_pk_fma_f32 v[152:153], v[128:129], v[96:97], v[152:153]
    v_pk_mul_f32 v[142:143], v[142:143], v[130:131]
    v_pk_mul_f32 v[144:145], v[144:145], v[132:133]
    v_pk_mul_f32 v[146:147], v[146:147], v[134:135]
    v_pk_mul_f32 v[148:149], v[148:149], v[136:137]
    v_pk_mul_f32 v[150:151], v[150:151], v[138:139]
    v_pk_mul_f32 v[152:153], v[152:153], v[140:141]
    v_cvt_pk_bf16_f32 v154, v152, v150
    v_cvt_pk_bf16_f32 v155, v148, v146
    v_cvt_pk_bf16_f32 v156, v144, v142
    v_cvt_pk_bf16_f32 v157, v153, v151
    v_cvt_pk_bf16_f32 v158, v149, v147
    v_cvt_pk_bf16_f32 v159, v145, v143
    ds_write_b32 v93, v155 offset:0
    ds_write_b32 v93, v158 offset:2560
    ds_write_b32 v94, v156 offset:0
    ds_write_b32 v94, v159 offset:2560
    s_mov_b32 exec_hi, 0xff
    ds_write_b32 v92, v154 offset:0
    ds_write_b32 v92, v157 offset:2560
    s_mov_b32 exec_hi, 0xfffffff
    v_lshlrev_b32 v112, 16, v13
    v_and_b32 v113, 0xffff0000, v13
    v_lshlrev_b32 v114, 16, v15
    v_and_b32 v115, 0xffff0000, v15
    v_lshlrev_b32 v116, 16, v17
    v_and_b32 v117, 0xffff0000, v17
    v_lshlrev_b32 v118, 16, v19
    v_and_b32 v119, 0xffff0000, v19
    v_lshlrev_b32 v120, 16, v21
    v_and_b32 v121, 0xffff0000, v21
    v_lshlrev_b32 v122, 16, v23
    v_and_b32 v123, 0xffff0000, v23
    v_lshlrev_b32 v124, 16, v25
    v_and_b32 v125, 0xffff0000, v25
    v_lshlrev_b32 v126, 16, v27
    v_and_b32 v127, 0xffff0000, v27
    v_lshlrev_b32 v128, 16, v29
    v_and_b32 v129, 0xffff0000, v29
    v_lshlrev_b32 v130, 16, v31
    v_and_b32 v131, 0xffff0000, v31
    v_lshlrev_b32 v132, 16, v33
    v_and_b32 v133, 0xffff0000, v33
    v_lshlrev_b32 v134, 16, v35
    v_and_b32 v135, 0xffff0000, v35
    v_lshlrev_b32 v136, 16, v37
    v_and_b32 v137, 0xffff0000, v37
    v_lshlrev_b32 v138, 16, v39
    v_and_b32 v139, 0xffff0000, v39
    v_lshlrev_b32 v140, 16, v41
    v_and_b32 v141, 0xffff0000, v41
    v_pk_mul_f32 v[142:143], v[112:113], v[110:111]
    v_pk_mul_f32 v[144:145], v[114:115], v[110:111]
    v_pk_mul_f32 v[146:147], v[116:117], v[110:111]
    v_pk_mul_f32 v[148:149], v[118:119], v[110:111]
    v_pk_mul_f32 v[150:151], v[120:121], v[110:111]
    v_pk_mul_f32 v[152:153], v[122:123], v[110:111]
    v_pk_fma_f32 v[142:143], v[114:115], v[106:107], v[142:143]
    v_pk_fma_f32 v[144:145], v[116:117], v[106:107], v[144:145]
    v_pk_fma_f32 v[146:147], v[118:119], v[106:107], v[146:147]
    v_pk_fma_f32 v[148:149], v[120:121], v[106:107], v[148:149]
    v_pk_fma_f32 v[150:151], v[122:123], v[106:107], v[150:151]
    v_pk_fma_f32 v[152:153], v[124:125], v[106:107], v[152:153]
    v_pk_fma_f32 v[142:143], v[116:117], v[102:103], v[142:143]
    v_pk_fma_f32 v[144:145], v[118:119], v[102:103], v[144:145]
    v_pk_fma_f32 v[146:147], v[120:121], v[102:103], v[146:147]
    v_pk_fma_f32 v[148:149], v[122:123], v[102:103], v[148:149]
    v_pk_fma_f32 v[150:151], v[124:125], v[102:103], v[150:151]
    v_pk_fma_f32 v[152:153], v[126:127], v[102:103], v[152:153]
    v_pk_fma_f32 v[142:143], v[118:119], v[98:99], v[142:143]
    v_pk_fma_f32 v[144:145], v[120:121], v[98:99], v[144:145]
    v_pk_fma_f32 v[146:147], v[122:123], v[98:99], v[146:147]
    v_pk_fma_f32 v[148:149], v[124:125], v[98:99], v[148:149]
    v_pk_fma_f32 v[150:151], v[126:127], v[98:99], v[150:151]
    v_pk_fma_f32 v[152:153], v[128:129], v[98:99], v[152:153]
    v_pk_mul_f32 v[142:143], v[142:143], v[130:131]
    v_pk_mul_f32 v[144:145], v[144:145], v[132:133]
    v_pk_mul_f32 v[146:147], v[146:147], v[134:135]
    v_pk_mul_f32 v[148:149], v[148:149], v[136:137]
    v_pk_mul_f32 v[150:151], v[150:151], v[138:139]
    v_pk_mul_f32 v[152:153], v[152:153], v[140:141]
    v_cvt_pk_bf16_f32 v154, v152, v150
    v_cvt_pk_bf16_f32 v155, v148, v146
    v_cvt_pk_bf16_f32 v156, v144, v142
    v_cvt_pk_bf16_f32 v157, v153, v151
    v_cvt_pk_bf16_f32 v158, v149, v147
    v_cvt_pk_bf16_f32 v159, v145, v143
    ds_write_b32 v93, v155 offset:5120
    ds_write_b32 v93, v158 offset:7680
    ds_write_b32 v94, v156 offset:5120
    ds_write_b32 v94, v159 offset:7680
    s_mov_b32 exec_hi, 0xff
    ds_write_b32 v92, v154 offset:5120
    ds_write_b32 v92, v157 offset:7680
    s_mov_b32 exec_hi, 0xfffffff
    s_mov_b64 exec, -1
    s_branch L_kvret
L_codeend:
.section .rodata,"a"
.p2align 6
.amdhsa_kernel gated_mix__ssm_conv_h3__glu_gated_glu__prompt_kernel
  .amdhsa_next_free_vgpr 256
  .amdhsa_next_free_sgpr 102
  .amdhsa_accum_offset 256
  .amdhsa_group_segment_fixed_size 0
  .amdhsa_kernarg_size 112
  .amdhsa_user_sgpr_count 2
  .amdhsa_user_sgpr_kernarg_segment_ptr 1
  .amdhsa_system_sgpr_workgroup_id_x 1
.end_amdhsa_kernel
```
